```python
import torch

def _softmax(x, axis=-1):
    return torch.softmax(x, dim=axis)
def _gelu(x):
    return torch.nn.functional.gelu(x, approximate="tanh")
def _silu(x):
    return torch.nn.functional.silu(x)
def _sigmoid(x):
    return torch.sigmoid(x)
def _layernorm(x, axis=-1, eps=1e-5):
    m = x.mean(dim=axis, keepdim=True)
    v = x.var(dim=axis, keepdim=True, unbiased=False)
    return (x - m) / torch.sqrt(v + eps)
def _scatter_add(tgt, idx, src, axis=0):
    return tgt.clone().index_add_(axis, idx, src)
def _segment_sum(src, seg, n):
    out = torch.zeros((n,) + src.shape[1:], dtype=src.dtype)
    return out.index_add_(0, seg, src)
def _pad(x, pw):
    flat = tuple(v for pair in reversed(pw) for v in pair)
    return torch.nn.functional.pad(x, flat)

kernel_name = 'gated_mix__mha_block_cached__glu_gated_swiglu__decode'

def setup_inputs():

    _w = (lambda a: (lambda t: t.to(torch.bfloat16) if t.is_floating_point() else t)(torch.as_tensor(a)))
    def _A_setup():
        B, Sq, D = 4, 1, 640
        H, Sk, Dh = 32, 8192, 192
        return {
            "x": _w((lambda *s: torch.randn(*s, dtype=torch.bfloat16) * 0.05)(B, Sq, D)),
            "k_cache": _w((lambda *s: torch.randn(*s, dtype=torch.bfloat16) * 6.4)(B, H, Sk, Dh)),
            "v_cache": _w((lambda *s: torch.randn(*s, dtype=torch.bfloat16) * 0.05)(B, H, Sk, Dh)),
            "wq": _w((lambda *s: torch.randn(*s, dtype=torch.bfloat16) * 6.4)(D, H * Dh) * (D ** -0.5)),
            "wo": _w((lambda *s: torch.randn(*s, dtype=torch.bfloat16) * 0.05)(H * Dh, D) * ((H * Dh) ** -0.5)),
        }
    _A_in = _A_setup()

    def _B_setup():
        B, S, D, F = 4, 1, 640, 1536
        return {
            "x": _w((lambda *s: torch.randn(*s, dtype=torch.bfloat16) * 0.05)(B, S, D)),
            "w1": _w((lambda *s: torch.randn(*s, dtype=torch.bfloat16) * 0.4)(D, F) * (2.0 / D) ** 0.5),
            "w3": _w((lambda *s: torch.randn(*s, dtype=torch.bfloat16) * 0.4)(D, F) * (2.0 / D) ** 0.5),
            "w2": _w((lambda *s: torch.randn(*s, dtype=torch.bfloat16) * 0.4)(F, D) * (2.0 / F) ** 0.5),
        }
    _B_in = _B_setup()

    return {
        "A_x": _A_in["x"],
        "A_k_cache": _A_in["k_cache"],
        "A_v_cache": _A_in["v_cache"],
        "A_wq": _A_in["wq"],
        "A_wo": _A_in["wo"],
        "B_x": _B_in["x"],
        "B_w1": _B_in["w1"],
        "B_w3": _B_in["w3"],
        "B_w2": _B_in["w2"],
        "gate_w": _w((lambda *s: torch.randn(*s, dtype=torch.bfloat16) * 0.05)(640) * 16.0),
    }

def reference(A_x, A_k_cache, A_v_cache, A_wq, A_wo, B_x, B_w1, B_w3, B_w2, gate_w):
    def _A_ref(x, k_cache, v_cache, wq, wo):
        B, Sq, D = x.shape
        H, Dh = 32, 192
        q = (lambda x, *d: x.permute(*d))((x @ wq).reshape(B, Sq, H, Dh), 0, 2, 1, 3)
        scores = torch.einsum("bhqd,bhkd->bhqk", q, k_cache) * (Dh ** -0.5)
        p = _softmax(scores, axis=-1)
        o = torch.einsum("bhqk,bhkd->bhqd", p, v_cache)
        return (lambda x, *d: x.permute(*d))(o, 0, 2, 1, 3).reshape(B, Sq, H * Dh) @ wo

    def _B_ref(x, w1, w3, w2):
        gate = torch.einsum("bsd,df->bsf", x, w1)
        up = torch.einsum("bsd,df->bsf", x, w3)
        h = _silu(gate) * up
        out = torch.einsum("bsf,fd->bsd", h, w2)
        return out

    x = A_x
    g = _sigmoid((x * gate_w).sum(-1, keepdims=True))
    a = _A_ref(x, A_k_cache, A_v_cache, A_wq, A_wo)
    b = _B_ref(x, B_w1, B_w3, B_w2)
    return g * a + (1 - g) * b
```

```asm
; @launch grid=(256,1,1) block=(512,1,1) lds=163840
.amdgcn_target "amdgcn-amd-amdhsa--gfx950"
.text
.globl gated_mix__mha_block_cached__glu_gated_swiglu__decode_kernel
.p2align 8
.type gated_mix__mha_block_cached__glu_gated_swiglu__decode_kernel,@function
gated_mix__mha_block_cached__glu_gated_swiglu__decode_kernel:
  s_cmp_ge_u32 s2, 256
  s_cbranch_scc1 L_end
  v_lshrrev_b32 v1, 6, v0
  v_and_b32 v0, 63, v0
  v_readfirstlane_b32 s3, v1
  s_nop 0
  s_cmp_lg_u32 s3, 3
  s_cbranch_scc1 L_nofl
  v_mov_b32 v12, 148992
  v_mov_b32 v16, 0
  v_mov_b32 v17, 0
  v_mov_b32 v18, 0
  v_mov_b32 v19, 0
  ds_write_b128 v12, v[16:19]
  ds_write_b128 v12, v[16:19] offset:16
  ds_write_b128 v12, v[16:19] offset:32
  s_waitcnt lgkmcnt(0)
L_nofl:
  s_mov_b32 s99, 3200000
  s_load_dwordx16 s[16:31], s[0:1], 0
  s_load_dwordx8 s[32:39], s[0:1], 64
  s_load_dwordx2 s[40:41], s[0:1], 96
  s_cmp_lt_u32 s3, 4
  s_cbranch_scc1 L_help
  s_memrealtime s[76:77]
  s_sub_u32 s43, s3, 4
  s_mov_b32 s63, s2
  s_lshr_b32 s58, s63, 3
  s_mul_i32 s50, s58, 3145728
  s_and_b32 s57, s63, 7
  s_lshl_b32 s57, s57, 2
  s_add_u32 s57, s57, s43
  s_mul_i32 s89, s58, 312
  s_add_u32 s89, s89, s57
  s_and_b32 s89, s89, 511
  s_mul_i32 s89, s89, 6144
  s_mov_b32 s54, s89
  s_mov_b32 s73, 0
  s_add_u32 s59, s54, 4096
  s_mov_b32 s88, 0
  s_mul_i32 s52, s43, 36864
  v_lshlrev_b32 v176, 4, v0
  v_lshrrev_b32 v177, 3, v0
  v_add_u32 v178, 0, v177
  v_mul_u32_u24 v178, 43, v178
  v_lshrrev_b32 v178, 8, v178
  v_and_b32 v179, 3, v178
  v_lshlrev_b32 v179, 5, v179
  v_xor_b32 v8, v176, v179
  v_lshlrev_b32 v178, 4, v178
  v_xor_b32 v2, v176, v178
  v_add_u32 v178, 8, v177
  v_mul_u32_u24 v178, 43, v178
  v_lshrrev_b32 v178, 8, v178
  v_and_b32 v179, 3, v178
  v_lshlrev_b32 v179, 5, v179
  v_xor_b32 v9, v176, v179
  v_lshlrev_b32 v178, 4, v178
  v_xor_b32 v3, v176, v178
  v_add_u32 v178, 16, v177
  v_mul_u32_u24 v178, 43, v178
  v_lshrrev_b32 v178, 8, v178
  v_and_b32 v179, 3, v178
  v_lshlrev_b32 v179, 5, v179
  v_xor_b32 v10, v176, v179
  v_lshlrev_b32 v178, 4, v178
  v_xor_b32 v4, v176, v178
  v_add_u32 v178, 24, v177
  v_mul_u32_u24 v178, 43, v178
  v_lshrrev_b32 v178, 8, v178
  v_lshlrev_b32 v178, 4, v178
  v_xor_b32 v5, v176, v178
  v_add_u32 v178, 32, v177
  v_mul_u32_u24 v178, 43, v178
  v_lshrrev_b32 v178, 8, v178
  v_lshlrev_b32 v178, 4, v178
  v_xor_b32 v6, v176, v178
  v_add_u32 v178, 40, v177
  v_mul_u32_u24 v178, 43, v178
  v_lshrrev_b32 v178, 8, v178
  v_lshlrev_b32 v178, 4, v178
  v_xor_b32 v7, v176, v178
  s_barrier
  s_waitcnt lgkmcnt(0)
  s_add_u32 s44, s18, s50
  s_addc_u32 s45, s19, 0
  s_sub_u32 s46, 402653184, s50
  s_mov_b32 s47, 0x00020000
  s_add_u32 s48, s20, s50
  s_addc_u32 s49, s21, 0
  s_mov_b32 s55, 5
  s_mov_b32 s62, s52
  s_add_u32 m0, s62, 0
  s_waitcnt vmcnt(5)
  buffer_load_dwordx4 v2, s[44:47], s54 offen offset:0 nt lds
  s_waitcnt vmcnt(5)
  buffer_load_dwordx4 v3, s[44:47], s54 offen offset:1024 nt lds
  s_waitcnt vmcnt(5)
  buffer_load_dwordx4 v4, s[44:47], s54 offen offset:2048 nt lds
  s_waitcnt vmcnt(5)
  buffer_load_dwordx4 v5, s[44:47], s54 offen offset:3072 nt lds
  s_add_u32 m0, s62, 4096
  s_waitcnt vmcnt(5)
  buffer_load_dwordx4 v6, s[44:47], s59 offen offset:0 nt lds
  s_waitcnt vmcnt(5)
  buffer_load_dwordx4 v7, s[44:47], s59 offen offset:1024 nt lds
  s_add_u32 s89, s89, 196608
  s_cmp_ge_u32 s89, 3145728
  s_cselect_b32 s57, 3145728, 0
  s_sub_u32 s89, s89, s57
  s_add_u32 s88, s88, 1
  s_and_b32 s57, s88, 15
  s_cselect_b32 s57, 0, 100663296
  s_add_u32 s73, s73, s57
  s_add_u32 s54, s73, s89
  s_add_u32 s59, s54, 4096
  s_add_u32 s62, s62, 6144
  v_and_b32 v176, 15, v0
  v_lshrrev_b32 v177, 4, v0
  v_mul_u32_u24 v178, 384, v176
  v_lshrrev_b32 v179, 1, v176
  v_xor_b32 v179, v179, v177
  v_lshl_add_u32 v11, v179, 4, v178
  v_add_u32 v11, s52, v11
  v_xor_b32 v12, 64, v11
  s_mov_b32 s53, 0
  v_lshrrev_b32 v178, 2, v0
  v_mul_u32_u24 v179, 384, v178
  v_and_b32 v180, 3, v0
  v_lshl_add_u32 v179, v180, 3, v179
  v_add_u32 v179, s52, v179
  v_bfe_u32 v180, v178, 1, 2
  v_xor_b32 v181, 0, v180
  v_lshl_add_u32 v13, v181, 5, v179
  v_xor_b32 v181, 1, v180
  v_lshl_add_u32 v14, v181, 5, v179
  v_xor_b32 v181, 2, v180
  v_lshl_add_u32 v15, v181, 5, v179
  v_xor_b32 v181, 3, v180
  v_lshl_add_u32 v16, v181, 5, v179
  v_lshlrev_b32 v21, 4, v177
  v_add_u32 v21, 147456, v21
  s_mov_b32 s64, s40
  s_mov_b32 s65, s41
  s_mov_b32 s66, 4194304
  s_mov_b32 s67, 0x00020000
  s_bfe_u32 s57, s2, 0x20003
  s_add_u32 s57, s57, s43
  s_cmp_eq_u32 s57, 0
  s_cselect_b32 s68, 1, 0
  s_lshr_b32 s57, s2, 5
  s_lshl_b32 s57, s57, 3
  s_and_b32 s69, s2, 7
  s_add_u32 s57, s57, s69
  s_lshl_b32 s57, s57, 3
  v_mov_b32 v182, s57
  v_lshlrev_b32 v183, 3, v0
  s_mov_b32 s69, 60
  s_mul_i32 s74, s58, 3
  s_add_u32 s74, s74, 1
  s_lshr_b32 s74, s74, 5
  s_mul_i32 s74, s74, 10
  s_cmp_eq_u32 s74, 0
  s_cselect_b32 s81, 5, 6
  s_mul_i32 s80, s81, 3
  s_movk_i32 s79, 1866
  s_add_u32 s78, s76, 220
  s_lshl_b32 s78, s78, 6
  s_add_u32 s85, s78, 0x400000
  s_mul_i32 s57, s80, s79
  s_add_u32 s78, s78, s57
  s_mov_b32 s58, 0
  s_mov_b32 s70, 0
  s_mov_b32 s71, 0
  s_mov_b32 s83, 0
  s_mov_b32 s84, 0
  s_mov_b32 s86, 0
  s_mov_b32 s87, 0
  s_mov_b32 s75, 303104
L_fill:
  s_add_u32 m0, s62, 0
  s_waitcnt vmcnt(5)
  buffer_load_dwordx4 v2, s[44:47], s54 offen offset:0 nt lds
  s_waitcnt vmcnt(5)
  buffer_load_dwordx4 v3, s[44:47], s54 offen offset:1024 nt lds
  s_waitcnt vmcnt(5)
  buffer_load_dwordx4 v4, s[44:47], s54 offen offset:2048 nt lds
  s_waitcnt vmcnt(5)
  buffer_load_dwordx4 v5, s[44:47], s54 offen offset:3072 nt lds
  s_add_u32 m0, s62, 4096
  s_waitcnt vmcnt(5)
  buffer_load_dwordx4 v6, s[44:47], s59 offen offset:0 nt lds
  s_waitcnt vmcnt(5)
  buffer_load_dwordx4 v7, s[44:47], s59 offen offset:1024 nt lds
  s_add_u32 s89, s89, 196608
  s_cmp_ge_u32 s89, 3145728
  s_cselect_b32 s57, 3145728, 0
  s_sub_u32 s89, s89, s57
  s_add_u32 s88, s88, 1
  s_and_b32 s57, s88, 15
  s_cselect_b32 s57, 0, 100663296
  s_add_u32 s73, s73, s57
  s_add_u32 s54, s73, s89
  s_add_u32 s59, s54, 4096
  s_add_u32 s62, s62, 6144
  s_sub_u32 s55, s55, 1
  s_cmp_lg_u32 s55, 0
  s_cbranch_scc1 L_fill
  s_branch L_stream2
L_help:
  s_setprio 3
  s_mov_b32 s60, 0x05040100
  s_mov_b32 s61, 0x07060302
  v_and_b32 v1, 15, v0
  v_lshrrev_b32 v2, 4, v0
  v_lshlrev_b32 v3, 4, v1
  v_lshlrev_b32 v4, 4, v2
  v_lshrrev_b32 v5, 2, v1
  v_and_b32 v6, 3, v0
  v_mov_b32 v11, 0
  s_mov_b32 s51, 400000
  s_barrier
  s_waitcnt lgkmcnt(0)
  s_load_dword s42, s[40:41], 0
  s_mov_b32 s64, s40
  s_mov_b32 s65, s41
  s_mov_b32 s66, 4194304
  s_mov_b32 s67, 0x00020000
  s_cmp_eq_u32 s3, 0
  s_cbranch_scc1 L_h0
  s_cmp_eq_u32 s3, 1
  s_cbranch_scc1 L_h1
  s_cmp_eq_u32 s3, 3
  s_cbranch_scc1 L_h3
L_h2:
  s_cmp_ge_u32 s2, 192
  s_cbranch_scc1 L_h3
  s_cmp_ge_u32 s2, 76
  s_cbranch_scc1 L_end
  v_mov_b32 v252, 148992
  s_mov_b32 s98, s99
L_h2w:
  ds_read_b32 v253, v252 offset:0
  s_waitcnt lgkmcnt(0)
  v_cmp_le_u32 vcc, 1, v253
  s_cbranch_vccnz L_h2wd
  s_sleep 8
  s_sub_u32 s98, s98, 1
  s_cmp_lg_u32 s98, 0
  s_cbranch_scc1 L_h2w
L_h2wd:
  v_mov_b32 v252, 148992
  s_mov_b32 s98, s99
L_h2sw:
  ds_read_b32 v253, v252 offset:24
  s_waitcnt lgkmcnt(0)
  v_cmp_le_u32 vcc, 1, v253
  s_cbranch_vccnz L_h2swd
  s_sleep 8
  s_sub_u32 s98, s98, 1
  s_cmp_lg_u32 s98, 0
  s_cbranch_scc1 L_h2sw
L_h2swd:
  s_sub_u32 s43, s2, 16
  s_add_u32 s76, s2, 256
  s_cmp_ge_u32 s2, 32
  s_cbranch_scc1 L_noq
  s_branch L_col
L_h0:
  s_mov_b32 s76, s2
  s_sub_u32 s43, s2, 240
L_col:
  s_lshr_b32 s44, s76, 1
  s_and_b32 s76, s76, 1
  s_cmp_ge_u32 s44, 120
  s_cselect_b32 s70, s30, s28
  s_cselect_b32 s71, s31, s29
  s_cselect_b32 s45, 60, 48
  s_cmp_ge_u32 s44, 96
  s_cselect_b32 s70, s70, s22
  s_cselect_b32 s71, s71, s23
  s_cselect_b32 s45, s45, 0
  s_cselect_b32 s77, 3, 12
  s_lshl_b32 s77, s77, 10
  s_lshl_b32 s45, s45, 1
  s_sub_u32 s46, s44, s45
  s_lshl_b32 s46, s46, 7
  s_mul_i32 s47, s77, 320
  s_mul_i32 s48, s47, s76
  s_add_u32 s46, s46, s48
  s_lshl_b32 s47, s47, 1
  s_add_u32 s68, s70, s46
  s_addc_u32 s69, s71, 0
  s_sub_u32 s70, s47, s46
  s_mov_b32 s71, 0x00020000
  v_lshrrev_b32 v9, 3, v1
  v_lshl_add_u32 v8, v9, 2, v2
  s_lshl_b32 s47, s77, 3
  v_mul_lo_u32 v8, v8, s47
  v_and_b32 v10, 7, v1
  v_lshl_add_u32 v8, v10, 4, v8
  v_mul_u32_u24 v7, 1280, v6
  v_and_b32 v11, 1, v5
  v_lshl_add_u32 v7, v11, 6, v7
  s_mul_i32 s47, s76, 640
  v_add3_u32 v7, v7, v4, s47
  global_load_dwordx4 v[12:15], v7, s[16:17] offset:0
  global_load_dwordx4 v[16:19], v7, s[16:17] offset:128
  global_load_dwordx4 v[20:23], v7, s[16:17] offset:256
  global_load_dwordx4 v[24:27], v7, s[16:17] offset:384
  global_load_dwordx4 v[28:31], v7, s[16:17] offset:512
  s_mul_i32 s78, s77, 56
  s_mov_b32 s48, 0
  buffer_load_dwordx4 v[32:35], v8, s[68:71], s48 offen nt
  s_add_u32 s48, s48, s77
  buffer_load_dwordx4 v[36:39], v8, s[68:71], s48 offen nt
  s_add_u32 s48, s48, s77
  buffer_load_dwordx4 v[40:43], v8, s[68:71], s48 offen nt
  s_add_u32 s48, s48, s77
  buffer_load_dwordx4 v[44:47], v8, s[68:71], s48 offen nt
  s_add_u32 s48, s48, s77
  buffer_load_dwordx4 v[48:51], v8, s[68:71], s48 offen nt
  s_add_u32 s48, s48, s77
  buffer_load_dwordx4 v[52:55], v8, s[68:71], s48 offen nt
  s_add_u32 s48, s48, s77
  buffer_load_dwordx4 v[56:59], v8, s[68:71], s48 offen nt
  s_add_u32 s48, s48, s77
  buffer_load_dwordx4 v[60:63], v8, s[68:71], s48 offen nt
  s_add_u32 s48, s48, s77
  s_add_u32 s48, s48, s78
  s_cmp_eq_u32 s3, 0
  s_cbranch_scc1 L_cw0
  s_waitcnt vmcnt(0)
L_cw0:
  buffer_load_dwordx4 v[64:67], v8, s[68:71], s48 offen nt
  s_add_u32 s48, s48, s77
  buffer_load_dwordx4 v[68:71], v8, s[68:71], s48 offen nt
  s_add_u32 s48, s48, s77
  buffer_load_dwordx4 v[72:75], v8, s[68:71], s48 offen nt
  s_add_u32 s48, s48, s77
  buffer_load_dwordx4 v[76:79], v8, s[68:71], s48 offen nt
  s_add_u32 s48, s48, s77
  buffer_load_dwordx4 v[80:83], v8, s[68:71], s48 offen nt
  s_add_u32 s48, s48, s77
  buffer_load_dwordx4 v[84:87], v8, s[68:71], s48 offen nt
  s_add_u32 s48, s48, s77
  buffer_load_dwordx4 v[88:91], v8, s[68:71], s48 offen nt
  s_add_u32 s48, s48, s77
  buffer_load_dwordx4 v[92:95], v8, s[68:71], s48 offen nt
  s_add_u32 s48, s48, s77
  s_add_u32 s48, s48, s78
  s_cmp_eq_u32 s3, 0
  s_cbranch_scc1 L_cw1
  s_waitcnt vmcnt(0)
L_cw1:
  buffer_load_dwordx4 v[96:99], v8, s[68:71], s48 offen nt
  s_add_u32 s48, s48, s77
  buffer_load_dwordx4 v[100:103], v8, s[68:71], s48 offen nt
  s_add_u32 s48, s48, s77
  buffer_load_dwordx4 v[104:107], v8, s[68:71], s48 offen nt
  s_add_u32 s48, s48, s77
  buffer_load_dwordx4 v[108:111], v8, s[68:71], s48 offen nt
  s_add_u32 s48, s48, s77
  buffer_load_dwordx4 v[112:115], v8, s[68:71], s48 offen nt
  s_add_u32 s48, s48, s77
  buffer_load_dwordx4 v[116:119], v8, s[68:71], s48 offen nt
  s_add_u32 s48, s48, s77
  buffer_load_dwordx4 v[120:123], v8, s[68:71], s48 offen nt
  s_add_u32 s48, s48, s77
  buffer_load_dwordx4 v[124:127], v8, s[68:71], s48 offen nt
  s_add_u32 s48, s48, s77
  s_add_u32 s48, s48, s78
  s_cmp_eq_u32 s3, 0
  s_cbranch_scc1 L_cw2
  s_waitcnt vmcnt(0)
L_cw2:
  buffer_load_dwordx4 v[128:131], v8, s[68:71], s48 offen nt
  s_add_u32 s48, s48, s77
  buffer_load_dwordx4 v[132:135], v8, s[68:71], s48 offen nt
  s_add_u32 s48, s48, s77
  buffer_load_dwordx4 v[136:139], v8, s[68:71], s48 offen nt
  s_add_u32 s48, s48, s77
  buffer_load_dwordx4 v[140:143], v8, s[68:71], s48 offen nt
  s_add_u32 s48, s48, s77
  buffer_load_dwordx4 v[144:147], v8, s[68:71], s48 offen nt
  s_add_u32 s48, s48, s77
  buffer_load_dwordx4 v[148:151], v8, s[68:71], s48 offen nt
  s_add_u32 s48, s48, s77
  buffer_load_dwordx4 v[152:155], v8, s[68:71], s48 offen nt
  s_add_u32 s48, s48, s77
  buffer_load_dwordx4 v[156:159], v8, s[68:71], s48 offen nt
  s_add_u32 s48, s48, s77
  s_add_u32 s48, s48, s78
  s_cmp_eq_u32 s3, 0
  s_cbranch_scc1 L_cw3
  s_waitcnt vmcnt(0)
L_cw3:
  buffer_load_dwordx4 v[160:163], v8, s[68:71], s48 offen nt
  s_add_u32 s48, s48, s77
  buffer_load_dwordx4 v[164:167], v8, s[68:71], s48 offen nt
  s_add_u32 s48, s48, s77
  buffer_load_dwordx4 v[168:171], v8, s[68:71], s48 offen nt
  s_add_u32 s48, s48, s77
  buffer_load_dwordx4 v[172:175], v8, s[68:71], s48 offen nt
  s_add_u32 s48, s48, s77
  buffer_load_dwordx4 v[176:179], v8, s[68:71], s48 offen nt
  s_add_u32 s48, s48, s77
  buffer_load_dwordx4 v[180:183], v8, s[68:71], s48 offen nt
  s_add_u32 s48, s48, s77
  buffer_load_dwordx4 v[184:187], v8, s[68:71], s48 offen nt
  s_add_u32 s48, s48, s77
  buffer_load_dwordx4 v[188:191], v8, s[68:71], s48 offen nt
  s_add_u32 s48, s48, s77
  v_lshlrev_b32 v9, 7, v1
  v_add_u32 v9, 161792, v9
  v_lshlrev_b32 v10, 6, v1
  v_lshl_add_u32 v10, v2, 2, v10
  v_add_u32 v10, 161792, v10
  v_mul_u32_u24 v11, 36864, v2
  v_add_u32 v11, v11, v3
  s_lshl_b32 s49, s44, 8
  s_mul_i32 s47, s76, 147456
  s_add_u32 s49, s49, s47
  s_add_u32 s49, s49, 4096
  s_movk_i32 s79, 0xff
  s_waitcnt vmcnt(32)
  v_perm_b32 v192, v36, v32, s60
  v_perm_b32 v193, v44, v40, s60
  v_perm_b32 v194, v52, v48, s60
  v_perm_b32 v195, v60, v56, s60
  v_perm_b32 v196, v36, v32, s61
  v_perm_b32 v197, v44, v40, s61
  v_perm_b32 v198, v52, v48, s61
  v_perm_b32 v199, v60, v56, s61
  v_mfma_f32_16x16x32_bf16 v[200:203], v[12:15], v[192:195], 0
  v_perm_b32 v192, v37, v33, s60
  v_perm_b32 v193, v45, v41, s60
  v_perm_b32 v194, v53, v49, s60
  v_perm_b32 v195, v61, v57, s60
  v_mfma_f32_16x16x32_bf16 v[204:207], v[12:15], v[196:199], 0
  v_perm_b32 v196, v37, v33, s61
  v_perm_b32 v197, v45, v41, s61
  v_perm_b32 v198, v53, v49, s61
  v_perm_b32 v199, v61, v57, s61
  v_mfma_f32_16x16x32_bf16 v[208:211], v[12:15], v[192:195], 0
  v_perm_b32 v192, v38, v34, s60
  v_perm_b32 v193, v46, v42, s60
  v_perm_b32 v194, v54, v50, s60
  v_perm_b32 v195, v62, v58, s60
  v_mfma_f32_16x16x32_bf16 v[212:215], v[12:15], v[196:199], 0
  v_perm_b32 v196, v38, v34, s61
  v_perm_b32 v197, v46, v42, s61
  v_perm_b32 v198, v54, v50, s61
  v_perm_b32 v199, v62, v58, s61
  v_mfma_f32_16x16x32_bf16 v[216:219], v[12:15], v[192:195], 0
  v_perm_b32 v192, v39, v35, s60
  v_perm_b32 v193, v47, v43, s60
  v_perm_b32 v194, v55, v51, s60
  v_perm_b32 v195, v63, v59, s60
  v_mfma_f32_16x16x32_bf16 v[220:223], v[12:15], v[196:199], 0
  v_perm_b32 v196, v39, v35, s61
  v_perm_b32 v197, v47, v43, s61
  v_perm_b32 v198, v55, v51, s61
  v_perm_b32 v199, v63, v59, s61
  v_mfma_f32_16x16x32_bf16 v[224:227], v[12:15], v[192:195], 0
  s_nop 1
  v_mfma_f32_16x16x32_bf16 v[228:231], v[12:15], v[196:199], 0
  s_waitcnt vmcnt(24)
  v_perm_b32 v192, v68, v64, s60
  v_perm_b32 v193, v76, v72, s60
  v_perm_b32 v194, v84, v80, s60
  v_perm_b32 v195, v92, v88, s60
  v_perm_b32 v196, v68, v64, s61
  v_perm_b32 v197, v76, v72, s61
  v_perm_b32 v198, v84, v80, s61
  v_perm_b32 v199, v92, v88, s61
  v_mfma_f32_16x16x32_bf16 v[200:203], v[16:19], v[192:195], v[200:203]
  v_perm_b32 v192, v69, v65, s60
  v_perm_b32 v193, v77, v73, s60
  v_perm_b32 v194, v85, v81, s60
  v_perm_b32 v195, v93, v89, s60
  v_mfma_f32_16x16x32_bf16 v[204:207], v[16:19], v[196:199], v[204:207]
  v_perm_b32 v196, v69, v65, s61
  v_perm_b32 v197, v77, v73, s61
  v_perm_b32 v198, v85, v81, s61
  v_perm_b32 v199, v93, v89, s61
  v_mfma_f32_16x16x32_bf16 v[208:211], v[16:19], v[192:195], v[208:211]
  v_perm_b32 v192, v70, v66, s60
  v_perm_b32 v193, v78, v74, s60
  v_perm_b32 v194, v86, v82, s60
  v_perm_b32 v195, v94, v90, s60
  v_mfma_f32_16x16x32_bf16 v[212:215], v[16:19], v[196:199], v[212:215]
  v_perm_b32 v196, v70, v66, s61
  v_perm_b32 v197, v78, v74, s61
  v_perm_b32 v198, v86, v82, s61
  v_perm_b32 v199, v94, v90, s61
  v_mfma_f32_16x16x32_bf16 v[216:219], v[16:19], v[192:195], v[216:219]
  v_perm_b32 v192, v71, v67, s60
  v_perm_b32 v193, v79, v75, s60
  v_perm_b32 v194, v87, v83, s60
  v_perm_b32 v195, v95, v91, s60
  v_mfma_f32_16x16x32_bf16 v[220:223], v[16:19], v[196:199], v[220:223]
  v_perm_b32 v196, v71, v67, s61
  v_perm_b32 v197, v79, v75, s61
  v_perm_b32 v198, v87, v83, s61
  v_perm_b32 v199, v95, v91, s61
  v_mfma_f32_16x16x32_bf16 v[224:227], v[16:19], v[192:195], v[224:227]
  s_nop 1
  v_mfma_f32_16x16x32_bf16 v[228:231], v[16:19], v[196:199], v[228:231]
  s_waitcnt vmcnt(16)
  v_perm_b32 v192, v100, v96, s60
  v_perm_b32 v193, v108, v104, s60
  v_perm_b32 v194, v116, v112, s60
  v_perm_b32 v195, v124, v120, s60
  v_perm_b32 v196, v100, v96, s61
  v_perm_b32 v197, v108, v104, s61
  v_perm_b32 v198, v116, v112, s61
  v_perm_b32 v199, v124, v120, s61
  v_mfma_f32_16x16x32_bf16 v[200:203], v[20:23], v[192:195], v[200:203]
  v_perm_b32 v192, v101, v97, s60
  v_perm_b32 v193, v109, v105, s60
  v_perm_b32 v194, v117, v113, s60
  v_perm_b32 v195, v125, v121, s60
  v_mfma_f32_16x16x32_bf16 v[204:207], v[20:23], v[196:199], v[204:207]
  v_perm_b32 v196, v101, v97, s61
  v_perm_b32 v197, v109, v105, s61
  v_perm_b32 v198, v117, v113, s61
  v_perm_b32 v199, v125, v121, s61
  v_mfma_f32_16x16x32_bf16 v[208:211], v[20:23], v[192:195], v[208:211]
  v_perm_b32 v192, v102, v98, s60
  v_perm_b32 v193, v110, v106, s60
  v_perm_b32 v194, v118, v114, s60
  v_perm_b32 v195, v126, v122, s60
  v_mfma_f32_16x16x32_bf16 v[212:215], v[20:23], v[196:199], v[212:215]
  v_perm_b32 v196, v102, v98, s61
  v_perm_b32 v197, v110, v106, s61
  v_perm_b32 v198, v118, v114, s61
  v_perm_b32 v199, v126, v122, s61
  v_mfma_f32_16x16x32_bf16 v[216:219], v[20:23], v[192:195], v[216:219]
  v_perm_b32 v192, v103, v99, s60
  v_perm_b32 v193, v111, v107, s60
  v_perm_b32 v194, v119, v115, s60
  v_perm_b32 v195, v127, v123, s60
  v_mfma_f32_16x16x32_bf16 v[220:223], v[20:23], v[196:199], v[220:223]
  v_perm_b32 v196, v103, v99, s61
  v_perm_b32 v197, v111, v107, s61
  v_perm_b32 v198, v119, v115, s61
  v_perm_b32 v199, v127, v123, s61
  v_mfma_f32_16x16x32_bf16 v[224:227], v[20:23], v[192:195], v[224:227]
  s_nop 1
  v_mfma_f32_16x16x32_bf16 v[228:231], v[20:23], v[196:199], v[228:231]
  s_waitcnt vmcnt(8)
  v_perm_b32 v192, v132, v128, s60
  v_perm_b32 v193, v140, v136, s60
  v_perm_b32 v194, v148, v144, s60
  v_perm_b32 v195, v156, v152, s60
  v_perm_b32 v196, v132, v128, s61
  v_perm_b32 v197, v140, v136, s61
  v_perm_b32 v198, v148, v144, s61
  v_perm_b32 v199, v156, v152, s61
  v_mfma_f32_16x16x32_bf16 v[200:203], v[24:27], v[192:195], v[200:203]
  v_perm_b32 v192, v133, v129, s60
  v_perm_b32 v193, v141, v137, s60
  v_perm_b32 v194, v149, v145, s60
  v_perm_b32 v195, v157, v153, s60
  v_mfma_f32_16x16x32_bf16 v[204:207], v[24:27], v[196:199], v[204:207]
  v_perm_b32 v196, v133, v129, s61
  v_perm_b32 v197, v141, v137, s61
  v_perm_b32 v198, v149, v145, s61
  v_perm_b32 v199, v157, v153, s61
  v_mfma_f32_16x16x32_bf16 v[208:211], v[24:27], v[192:195], v[208:211]
  v_perm_b32 v192, v134, v130, s60
  v_perm_b32 v193, v142, v138, s60
  v_perm_b32 v194, v150, v146, s60
  v_perm_b32 v195, v158, v154, s60
  v_mfma_f32_16x16x32_bf16 v[212:215], v[24:27], v[196:199], v[212:215]
  v_perm_b32 v196, v134, v130, s61
  v_perm_b32 v197, v142, v138, s61
  v_perm_b32 v198, v150, v146, s61
  v_perm_b32 v199, v158, v154, s61
  v_mfma_f32_16x16x32_bf16 v[216:219], v[24:27], v[192:195], v[216:219]
  v_perm_b32 v192, v135, v131, s60
  v_perm_b32 v193, v143, v139, s60
  v_perm_b32 v194, v151, v147, s60
  v_perm_b32 v195, v159, v155, s60
  v_mfma_f32_16x16x32_bf16 v[220:223], v[24:27], v[196:199], v[220:223]
  v_perm_b32 v196, v135, v131, s61
  v_perm_b32 v197, v143, v139, s61
  v_perm_b32 v198, v151, v147, s61
  v_perm_b32 v199, v159, v155, s61
  v_mfma_f32_16x16x32_bf16 v[224:227], v[24:27], v[192:195], v[224:227]
  s_nop 1
  v_mfma_f32_16x16x32_bf16 v[228:231], v[24:27], v[196:199], v[228:231]
  s_waitcnt vmcnt(0)
  v_perm_b32 v192, v164, v160, s60
  v_perm_b32 v193, v172, v168, s60
  v_perm_b32 v194, v180, v176, s60
  v_perm_b32 v195, v188, v184, s60
  v_perm_b32 v196, v164, v160, s61
  v_perm_b32 v197, v172, v168, s61
  v_perm_b32 v198, v180, v176, s61
  v_perm_b32 v199, v188, v184, s61
  v_mfma_f32_16x16x32_bf16 v[200:203], v[28:31], v[192:195], v[200:203]
  v_perm_b32 v192, v165, v161, s60
  v_perm_b32 v193, v173, v169, s60
  v_perm_b32 v194, v181, v177, s60
  v_perm_b32 v195, v189, v185, s60
  v_mfma_f32_16x16x32_bf16 v[204:207], v[28:31], v[196:199], v[204:207]
  v_perm_b32 v196, v165, v161, s61
  v_perm_b32 v197, v173, v169, s61
  v_perm_b32 v198, v181, v177, s61
  v_perm_b32 v199, v189, v185, s61
  v_mfma_f32_16x16x32_bf16 v[208:211], v[28:31], v[192:195], v[208:211]
  v_perm_b32 v192, v166, v162, s60
  v_perm_b32 v193, v174, v170, s60
  v_perm_b32 v194, v182, v178, s60
  v_perm_b32 v195, v190, v186, s60
  v_mfma_f32_16x16x32_bf16 v[212:215], v[28:31], v[196:199], v[212:215]
  v_perm_b32 v196, v166, v162, s61
  v_perm_b32 v197, v174, v170, s61
  v_perm_b32 v198, v182, v178, s61
  v_perm_b32 v199, v190, v186, s61
  v_mfma_f32_16x16x32_bf16 v[216:219], v[28:31], v[192:195], v[216:219]
  v_perm_b32 v192, v167, v163, s60
  v_perm_b32 v193, v175, v171, s60
  v_perm_b32 v194, v183, v179, s60
  v_perm_b32 v195, v191, v187, s60
  v_mfma_f32_16x16x32_bf16 v[220:223], v[28:31], v[196:199], v[220:223]
  v_perm_b32 v196, v167, v163, s61
  v_perm_b32 v197, v175, v171, s61
  v_perm_b32 v198, v183, v179, s61
  v_perm_b32 v199, v191, v187, s61
  v_mfma_f32_16x16x32_bf16 v[224:227], v[28:31], v[192:195], v[224:227]
  s_nop 1
  v_mfma_f32_16x16x32_bf16 v[228:231], v[28:31], v[196:199], v[228:231]
  s_mov_b32 exec_lo, 0xff0000ff
  s_mov_b32 exec_hi, 0
  s_nop 5
  ds_write_b128 v9, v[200:203] offset:0
  ds_write_b128 v9, v[204:207] offset:16
  ds_write_b128 v9, v[208:211] offset:32
  ds_write_b128 v9, v[212:215] offset:48
  ds_write_b128 v9, v[216:219] offset:64
  ds_write_b128 v9, v[220:223] offset:80
  ds_write_b128 v9, v[224:227] offset:96
  ds_write_b128 v9, v[228:231] offset:112
  s_mov_b64 exec, -1
  ds_read_b32 v32, v10 offset:0
  ds_read_b32 v33, v10 offset:16
  ds_read_b32 v34, v10 offset:32
  ds_read_b32 v35, v10 offset:48
  ds_read_b32 v36, v10 offset:1024
  ds_read_b32 v37, v10 offset:1040
  ds_read_b32 v38, v10 offset:1056
  ds_read_b32 v39, v10 offset:1072
  s_waitcnt lgkmcnt(0)
  s_add_u32 s47, s42, 1
  v_mov_b32 v40, s47
  v_add_f32 v32, v32, v36
  v_add_f32 v33, v33, v37
  v_add_f32 v34, v34, v38
  v_add_f32 v35, v35, v39
  v_bfi_b32 v32, s79, v40, v32
  v_bfi_b32 v33, s79, v40, v33
  v_bfi_b32 v34, s79, v40, v34
  v_bfi_b32 v35, s79, v40, v35
  buffer_store_dwordx4 v[32:35], v11, s[64:67], s49 offen sc1
  v_mov_b32 v41, 148992
  ds_write_b32 v41, v41 offset:24
  s_cmp_lg_u32 s3, 0
  s_cbranch_scc1 L_hend
L_noq:
  s_add_u32 s42, s42, 1
  v_mov_b32 v7, s42
  s_movk_i32 s79, 0xff
  v_mul_u32_u24 v9, 2560, v2
  v_add_u32 v9, v9, v3
  s_mov_b32 s47, 10240
  v_mad_u32_u24 v8, v2, s47, v3
  s_and_b32 s76, s2, 7
  s_mul_i32 s76, s76, 30
  s_lshr_b32 s77, s2, 3
  s_add_u32 s76, s76, s77
  s_cmp_lt_u32 s43, 60
  s_cselect_b32 s76, s43, s76
  s_cselect_b32 s70, s32, s24
  s_cselect_b32 s71, s33, s25
  s_cselect_b32 s77, 1, 4
  s_cselect_b32 s78, 48, 0
  s_mul_i32 s77, s77, 1966080
  s_mul_i32 s44, s76, 13108
  s_lshr_b32 s44, s44, 16
  s_mul_i32 s45, s44, 5
  s_sub_u32 s45, s76, s45
  s_mul_i32 s46, s44, 163840
  s_lshl_b32 s47, s45, 8
  s_add_u32 s46, s46, s47
  s_add_u32 s68, s70, s46
  s_addc_u32 s69, s71, 0
  s_sub_u32 s70, s77, s46
  s_mov_b32 s71, 0x00020000
  s_add_u32 s49, s44, s78
  s_mul_i32 s49, s49, 10240
  s_lshl_b32 s50, s45, 9
  s_add_u32 s49, s49, s50
  s_add_u32 s49, s49, 327680
  s_cmp_lt_u32 s43, 60
  s_cbranch_scc1 L_w2
  s_lshl_b32 s46, s44, 1
  s_add_u32 s46, s46, 0
  s_mul_i32 s47, s46, 21846
  s_lshr_b32 s47, s47, 16
  s_mul_i32 s48, s47, 3
  s_sub_u32 s48, s46, s48
  s_mul_i32 s47, s47, 24576
  s_lshl_b32 s48, s48, 8
  s_add_u32 s47, s47, s48
  s_add_u32 s72, s47, 983040
  s_add_u32 s73, s47, 995328
  s_lshl_b32 s46, s44, 1
  s_add_u32 s46, s46, 1
  s_mul_i32 s47, s46, 21846
  s_lshr_b32 s47, s47, 16
  s_mul_i32 s48, s47, 3
  s_sub_u32 s48, s46, s48
  s_mul_i32 s47, s47, 24576
  s_lshl_b32 s48, s48, 8
  s_add_u32 s47, s47, s48
  s_add_u32 s74, s47, 983040
  s_add_u32 s75, s47, 995328
  v_mul_u32_u24 v11, 12, v2
  v_add_u32 v11, v11, v1
  v_lshlrev_b32 v11, 4, v11
  v_add_u32 v11, 149504, v11
  s_mov_b32 s94, 0x0fff0fff
  s_mov_b32 s95, 0x0fff0fff
  v_cmp_le_u32 vcc, 2, v5
  v_mov_b32 v10, s72
  v_mov_b32 v12, s74
  v_cndmask_b32 v10, v10, v12, vcc
  v_and_b32 v12, 1, v5
  v_lshl_add_u32 v10, v12, 7, v10
  v_lshl_add_u32 v10, v2, 5, v10
  v_mul_u32_u24 v12, 3072, v6
  v_add_u32 v10, v10, v12
  s_movk_i32 s80, 2304
  s_movk_i32 s81, 14592
  s_mov_b32 s82, 0xffff0000
L_tile:
  s_mov_b32 s48, 0
  v_mov_b32 v252, 148992
  s_mov_b32 s98, s99
L_ltw:
  ds_read_b32 v253, v252 offset:4
  s_waitcnt lgkmcnt(0)
  v_cmp_le_u32 vcc, 4, v253
  s_cbranch_vccnz L_ltwd
  s_sleep 2
  s_sub_u32 s98, s98, 1
  s_cmp_lg_u32 s98, 0
  s_cbranch_scc1 L_ltw
L_ltwd:
  s_cmp_eq_u32 s3, 0
  s_cbranch_scc1 L_l2wd
  v_mov_b32 v252, 148992
  s_mov_b32 s98, s99
L_l2w:
  ds_read_b32 v253, v252 offset:8
  s_waitcnt lgkmcnt(0)
  v_cmp_le_u32 vcc, 1, v253
  s_cbranch_vccnz L_l2wd
  s_sleep 2
  s_sub_u32 s98, s98, 1
  s_cmp_lg_u32 s98, 0
  s_cbranch_scc1 L_l2w
L_l2wd:
  buffer_load_dwordx4 v[60:63], v8, s[68:71], s48 offen nt
  s_add_u32 s48, s48, 1280
  buffer_load_dwordx4 v[64:67], v8, s[68:71], s48 offen nt
  s_add_u32 s48, s48, 1280
  buffer_load_dwordx4 v[68:71], v8, s[68:71], s48 offen nt
  s_add_u32 s48, s48, 1280
  buffer_load_dwordx4 v[72:75], v8, s[68:71], s48 offen nt
  s_add_u32 s48, s48, 1280
  buffer_load_dwordx4 v[76:79], v8, s[68:71], s48 offen nt
  s_add_u32 s48, s48, 1280
  buffer_load_dwordx4 v[80:83], v8, s[68:71], s48 offen nt
  s_add_u32 s48, s48, 1280
  buffer_load_dwordx4 v[84:87], v8, s[68:71], s48 offen nt
  s_add_u32 s48, s48, 1280
  buffer_load_dwordx4 v[88:91], v8, s[68:71], s48 offen nt
  s_add_u32 s48, s48, 1280
  s_add_u32 s48, s48, 30720
  buffer_load_dwordx4 v[92:95], v8, s[68:71], s48 offen nt
  s_add_u32 s48, s48, 1280
  buffer_load_dwordx4 v[96:99], v8, s[68:71], s48 offen nt
  s_add_u32 s48, s48, 1280
  buffer_load_dwordx4 v[100:103], v8, s[68:71], s48 offen nt
  s_add_u32 s48, s48, 1280
  buffer_load_dwordx4 v[104:107], v8, s[68:71], s48 offen nt
  s_add_u32 s48, s48, 1280
  buffer_load_dwordx4 v[108:111], v8, s[68:71], s48 offen nt
  s_add_u32 s48, s48, 1280
  buffer_load_dwordx4 v[112:115], v8, s[68:71], s48 offen nt
  s_add_u32 s48, s48, 1280
  buffer_load_dwordx4 v[116:119], v8, s[68:71], s48 offen nt
  s_add_u32 s48, s48, 1280
  buffer_load_dwordx4 v[120:123], v8, s[68:71], s48 offen nt
  s_add_u32 s48, s48, 1280
  s_add_u32 s48, s48, 30720
  buffer_load_dwordx4 v[124:127], v8, s[68:71], s48 offen nt
  s_add_u32 s48, s48, 1280
  buffer_load_dwordx4 v[128:131], v8, s[68:71], s48 offen nt
  s_add_u32 s48, s48, 1280
  buffer_load_dwordx4 v[132:135], v8, s[68:71], s48 offen nt
  s_add_u32 s48, s48, 1280
  buffer_load_dwordx4 v[136:139], v8, s[68:71], s48 offen nt
  s_add_u32 s48, s48, 1280
  buffer_load_dwordx4 v[140:143], v8, s[68:71], s48 offen nt
  s_add_u32 s48, s48, 1280
  buffer_load_dwordx4 v[144:147], v8, s[68:71], s48 offen nt
  s_add_u32 s48, s48, 1280
  buffer_load_dwordx4 v[148:151], v8, s[68:71], s48 offen nt
  s_add_u32 s48, s48, 1280
  buffer_load_dwordx4 v[152:155], v8, s[68:71], s48 offen nt
  s_add_u32 s48, s48, 1280
  s_add_u32 s48, s48, 30720
  buffer_load_dwordx4 v[156:159], v8, s[68:71], s48 offen nt
  s_add_u32 s48, s48, 1280
  buffer_load_dwordx4 v[160:163], v8, s[68:71], s48 offen nt
  s_add_u32 s48, s48, 1280
  buffer_load_dwordx4 v[164:167], v8, s[68:71], s48 offen nt
  s_add_u32 s48, s48, 1280
  buffer_load_dwordx4 v[168:171], v8, s[68:71], s48 offen nt
  s_add_u32 s48, s48, 1280
  buffer_load_dwordx4 v[172:175], v8, s[68:71], s48 offen nt
  s_add_u32 s48, s48, 1280
  buffer_load_dwordx4 v[176:179], v8, s[68:71], s48 offen nt
  s_add_u32 s48, s48, 1280
  buffer_load_dwordx4 v[180:183], v8, s[68:71], s48 offen nt
  s_add_u32 s48, s48, 1280
  buffer_load_dwordx4 v[184:187], v8, s[68:71], s48 offen nt
  s_add_u32 s48, s48, 1280
  s_waitcnt vmcnt(24)
  v_perm_b32 v28, v64, v60, s60
  v_perm_b32 v29, v72, v68, s60
  v_perm_b32 v30, v80, v76, s60
  v_perm_b32 v31, v88, v84, s60
  v_perm_b32 v32, v64, v60, s61
  v_perm_b32 v33, v72, v68, s61
  v_perm_b32 v34, v80, v76, s61
  v_perm_b32 v35, v88, v84, s61
  v_perm_b32 v36, v65, v61, s60
  v_perm_b32 v37, v73, v69, s60
  v_perm_b32 v38, v81, v77, s60
  v_perm_b32 v39, v89, v85, s60
  v_perm_b32 v40, v65, v61, s61
  v_perm_b32 v41, v73, v69, s61
  v_perm_b32 v42, v81, v77, s61
  v_perm_b32 v43, v89, v85, s61
  v_perm_b32 v44, v66, v62, s60
  v_perm_b32 v45, v74, v70, s60
  v_perm_b32 v46, v82, v78, s60
  v_perm_b32 v47, v90, v86, s60
  v_perm_b32 v48, v66, v62, s61
  v_perm_b32 v49, v74, v70, s61
  v_perm_b32 v50, v82, v78, s61
  v_perm_b32 v51, v90, v86, s61
  v_perm_b32 v52, v67, v63, s60
  v_perm_b32 v53, v75, v71, s60
  v_perm_b32 v54, v83, v79, s60
  v_perm_b32 v55, v91, v87, s60
  v_perm_b32 v56, v67, v63, s61
  v_perm_b32 v57, v75, v71, s61
  v_perm_b32 v58, v83, v79, s61
  v_perm_b32 v59, v91, v87, s61
  s_waitcnt vmcnt(16)
  v_perm_b32 v60, v96, v92, s60
  v_perm_b32 v61, v104, v100, s60
  v_perm_b32 v62, v112, v108, s60
  v_perm_b32 v63, v120, v116, s60
  v_perm_b32 v64, v96, v92, s61
  v_perm_b32 v65, v104, v100, s61
  v_perm_b32 v66, v112, v108, s61
  v_perm_b32 v67, v120, v116, s61
  v_perm_b32 v68, v97, v93, s60
  v_perm_b32 v69, v105, v101, s60
  v_perm_b32 v70, v113, v109, s60
  v_perm_b32 v71, v121, v117, s60
  v_perm_b32 v72, v97, v93, s61
  v_perm_b32 v73, v105, v101, s61
  v_perm_b32 v74, v113, v109, s61
  v_perm_b32 v75, v121, v117, s61
  v_perm_b32 v76, v98, v94, s60
  v_perm_b32 v77, v106, v102, s60
  v_perm_b32 v78, v114, v110, s60
  v_perm_b32 v79, v122, v118, s60
  v_perm_b32 v80, v98, v94, s61
  v_perm_b32 v81, v106, v102, s61
  v_perm_b32 v82, v114, v110, s61
  v_perm_b32 v83, v122, v118, s61
  v_perm_b32 v84, v99, v95, s60
  v_perm_b32 v85, v107, v103, s60
  v_perm_b32 v86, v115, v111, s60
  v_perm_b32 v87, v123, v119, s60
  v_perm_b32 v88, v99, v95, s61
  v_perm_b32 v89, v107, v103, s61
  v_perm_b32 v90, v115, v111, s61
  v_perm_b32 v91, v123, v119, s61
  s_waitcnt vmcnt(8)
  v_perm_b32 v92, v128, v124, s60
  v_perm_b32 v93, v136, v132, s60
  v_perm_b32 v94, v144, v140, s60
  v_perm_b32 v95, v152, v148, s60
  v_perm_b32 v96, v128, v124, s61
  v_perm_b32 v97, v136, v132, s61
  v_perm_b32 v98, v144, v140, s61
  v_perm_b32 v99, v152, v148, s61
  v_perm_b32 v100, v129, v125, s60
  v_perm_b32 v101, v137, v133, s60
  v_perm_b32 v102, v145, v141, s60
  v_perm_b32 v103, v153, v149, s60
  v_perm_b32 v104, v129, v125, s61
  v_perm_b32 v105, v137, v133, s61
  v_perm_b32 v106, v145, v141, s61
  v_perm_b32 v107, v153, v149, s61
  v_perm_b32 v108, v130, v126, s60
  v_perm_b32 v109, v138, v134, s60
  v_perm_b32 v110, v146, v142, s60
  v_perm_b32 v111, v154, v150, s60
  v_perm_b32 v112, v130, v126, s61
  v_perm_b32 v113, v138, v134, s61
  v_perm_b32 v114, v146, v142, s61
  v_perm_b32 v115, v154, v150, s61
  v_perm_b32 v116, v131, v127, s60
  v_perm_b32 v117, v139, v135, s60
  v_perm_b32 v118, v147, v143, s60
  v_perm_b32 v119, v155, v151, s60
  v_perm_b32 v120, v131, v127, s61
  v_perm_b32 v121, v139, v135, s61
  v_perm_b32 v122, v147, v143, s61
  v_perm_b32 v123, v155, v151, s61
  s_waitcnt vmcnt(0)
  v_perm_b32 v124, v160, v156, s60
  v_perm_b32 v125, v168, v164, s60
  v_perm_b32 v126, v176, v172, s60
  v_perm_b32 v127, v184, v180, s60
  v_perm_b32 v128, v160, v156, s61
  v_perm_b32 v129, v168, v164, s61
  v_perm_b32 v130, v176, v172, s61
  v_perm_b32 v131, v184, v180, s61
  v_perm_b32 v132, v161, v157, s60
  v_perm_b32 v133, v169, v165, s60
  v_perm_b32 v134, v177, v173, s60
  v_perm_b32 v135, v185, v181, s60
  v_perm_b32 v136, v161, v157, s61
  v_perm_b32 v137, v169, v165, s61
  v_perm_b32 v138, v177, v173, s61
  v_perm_b32 v139, v185, v181, s61
  v_perm_b32 v140, v162, v158, s60
  v_perm_b32 v141, v170, v166, s60
  v_perm_b32 v142, v178, v174, s60
  v_perm_b32 v143, v186, v182, s60
  v_perm_b32 v144, v162, v158, s61
  v_perm_b32 v145, v170, v166, s61
  v_perm_b32 v146, v178, v174, s61
  v_perm_b32 v147, v186, v182, s61
  v_perm_b32 v148, v163, v159, s60
  v_perm_b32 v149, v171, v167, s60
  v_perm_b32 v150, v179, v175, s60
  v_perm_b32 v151, v187, v183, s60
  v_perm_b32 v152, v163, v159, s61
  v_perm_b32 v153, v171, v167, s61
  v_perm_b32 v154, v179, v175, s61
  v_perm_b32 v155, v187, v183, s61
  s_cmp_lt_u32 s43, 60
  s_cbranch_scc1 L_w2b
  buffer_load_dwordx4 v[188:191], v10, s[64:67], s80 offen offset:0 sc1
  buffer_load_dwordx4 v[192:195], v10, s[64:67], s80 offen offset:16 sc1
  buffer_load_dwordx4 v[196:199], v10, s[64:67], s81 offen offset:0 sc1
  buffer_load_dwordx4 v[200:203], v10, s[64:67], s81 offen offset:16 sc1
  v_mov_b32 v252, 148992
  s_mov_b32 s98, s99
L_aw:
  ds_read_b32 v253, v252 offset:32
  s_waitcnt lgkmcnt(0)
  v_cmp_le_u32 vcc, 1, v253
  s_cbranch_vccnz L_awd
  s_sleep 1
  s_sub_u32 s98, s98, 1
  s_cmp_lg_u32 s98, 0
  s_cbranch_scc1 L_aw
L_awd:
  s_mov_b64 exec, s[94:95]
  ds_read_b128 v[12:15], v11 offset:0
  ds_read_b128 v[16:19], v11 offset:3072
  ds_read_b128 v[20:23], v11 offset:6144
  ds_read_b128 v[24:27], v11 offset:9216
  s_mov_b64 s[96:97], -1
  s_mov_b64 exec, -1
  s_branch L_h0chk
L_h0poll:
  s_mov_b64 exec, s[96:97]
  buffer_load_dwordx4 v[188:191], v10, s[64:67], s80 offen offset:0 sc1
  buffer_load_dwordx4 v[192:195], v10, s[64:67], s80 offen offset:16 sc1
  buffer_load_dwordx4 v[196:199], v10, s[64:67], s81 offen offset:0 sc1
  buffer_load_dwordx4 v[200:203], v10, s[64:67], s81 offen offset:16 sc1
L_h0chk:
  s_waitcnt vmcnt(0)
  v_cmpx_eq_u32 vcc, s42, v189
  v_cmpx_eq_u32 vcc, s42, v191
  v_cmpx_eq_u32 vcc, s42, v193
  v_cmpx_eq_u32 vcc, s42, v195
  v_cmpx_eq_u32 vcc, s42, v197
  v_cmpx_eq_u32 vcc, s42, v199
  v_cmpx_eq_u32 vcc, s42, v201
  v_cmpx_eq_u32 vcc, s42, v203
  s_nop 1
  s_andn2_b64 s[96:97], s[96:97], exec
  s_cbranch_scc0 L_h0go
  s_sleep 2
  s_sub_u32 s51, s51, 1
  s_cmp_lg_u32 s51, 0
  s_cbranch_scc1 L_h0poll
L_h0go:
  s_mov_b64 exec, -1
  s_nop 3
  s_waitcnt lgkmcnt(0)
  v_lshlrev_b32 v189, 16, v188
  v_lshlrev_b32 v197, 16, v196
  v_and_b32 v188, s82, v188
  v_and_b32 v196, s82, v196
  v_add_f32 v189, v189, v197
  v_add_f32 v188, v188, v196
  v_cvt_pk_bf16_f32 v204, v189, v188
  v_lshlrev_b32 v191, 16, v190
  v_lshlrev_b32 v199, 16, v198
  v_and_b32 v190, s82, v190
  v_and_b32 v198, s82, v198
  v_add_f32 v191, v191, v199
  v_add_f32 v190, v190, v198
  v_cvt_pk_bf16_f32 v205, v191, v190
  v_lshlrev_b32 v193, 16, v192
  v_lshlrev_b32 v201, 16, v200
  v_and_b32 v192, s82, v192
  v_and_b32 v200, s82, v200
  v_add_f32 v193, v193, v201
  v_add_f32 v192, v192, v200
  v_cvt_pk_bf16_f32 v206, v193, v192
  v_lshlrev_b32 v195, 16, v194
  v_lshlrev_b32 v203, 16, v202
  v_and_b32 v194, s82, v194
  v_and_b32 v202, s82, v202
  v_add_f32 v195, v195, v203
  v_add_f32 v194, v194, v202
  v_cvt_pk_bf16_f32 v207, v195, v194
  s_nop 1
  v_mov_b32_dpp v12, v204 row_shr:12 row_mask:0xf bank_mask:0x8
  v_mov_b32_dpp v13, v205 row_shr:12 row_mask:0xf bank_mask:0x8
  v_mov_b32_dpp v14, v206 row_shr:12 row_mask:0xf bank_mask:0x8
  v_mov_b32_dpp v15, v207 row_shr:12 row_mask:0xf bank_mask:0x8
  v_mov_b32_dpp v16, v204 row_shr:8 row_mask:0xf bank_mask:0x8
  v_mov_b32_dpp v17, v205 row_shr:8 row_mask:0xf bank_mask:0x8
  v_mfma_f32_16x16x32_bf16 v[156:159], v[12:15], v[28:31], 0
  v_mov_b32_dpp v18, v206 row_shr:8 row_mask:0xf bank_mask:0x8
  v_mov_b32_dpp v19, v207 row_shr:8 row_mask:0xf bank_mask:0x8
  v_mfma_f32_16x16x32_bf16 v[160:163], v[12:15], v[32:35], 0
  v_mov_b32_dpp v20, v204 row_shr:4 row_mask:0xf bank_mask:0x8
  v_mov_b32_dpp v21, v205 row_shr:4 row_mask:0xf bank_mask:0x8
  v_mfma_f32_16x16x32_bf16 v[164:167], v[12:15], v[36:39], 0
  v_mov_b32_dpp v22, v206 row_shr:4 row_mask:0xf bank_mask:0x8
  v_mov_b32_dpp v23, v207 row_shr:4 row_mask:0xf bank_mask:0x8
  v_mfma_f32_16x16x32_bf16 v[168:171], v[12:15], v[40:43], 0
  v_mov_b32_dpp v24, v204 quad_perm:[0,1,2,3] row_mask:0xf bank_mask:0x8
  v_mov_b32_dpp v25, v205 quad_perm:[0,1,2,3] row_mask:0xf bank_mask:0x8
  v_mfma_f32_16x16x32_bf16 v[172:175], v[12:15], v[44:47], 0
  v_mov_b32_dpp v26, v206 quad_perm:[0,1,2,3] row_mask:0xf bank_mask:0x8
  v_mov_b32_dpp v27, v207 quad_perm:[0,1,2,3] row_mask:0xf bank_mask:0x8
  v_mfma_f32_16x16x32_bf16 v[176:179], v[12:15], v[48:51], 0
  v_mfma_f32_16x16x32_bf16 v[180:183], v[12:15], v[52:55], 0
  v_mfma_f32_16x16x32_bf16 v[184:187], v[12:15], v[56:59], 0
  v_mfma_f32_16x16x32_bf16 v[156:159], v[16:19], v[60:63], v[156:159]
  v_mfma_f32_16x16x32_bf16 v[160:163], v[16:19], v[64:67], v[160:163]
  v_mfma_f32_16x16x32_bf16 v[164:167], v[16:19], v[68:71], v[164:167]
  v_mfma_f32_16x16x32_bf16 v[168:171], v[16:19], v[72:75], v[168:171]
  v_mfma_f32_16x16x32_bf16 v[172:175], v[16:19], v[76:79], v[172:175]
  v_mfma_f32_16x16x32_bf16 v[176:179], v[16:19], v[80:83], v[176:179]
  v_mfma_f32_16x16x32_bf16 v[180:183], v[16:19], v[84:87], v[180:183]
  v_mfma_f32_16x16x32_bf16 v[184:187], v[16:19], v[88:91], v[184:187]
  v_mfma_f32_16x16x32_bf16 v[156:159], v[20:23], v[92:95], v[156:159]
  v_mfma_f32_16x16x32_bf16 v[160:163], v[20:23], v[96:99], v[160:163]
  v_mfma_f32_16x16x32_bf16 v[164:167], v[20:23], v[100:103], v[164:167]
  v_mfma_f32_16x16x32_bf16 v[168:171], v[20:23], v[104:107], v[168:171]
  v_mfma_f32_16x16x32_bf16 v[172:175], v[20:23], v[108:111], v[172:175]
  v_mfma_f32_16x16x32_bf16 v[176:179], v[20:23], v[112:115], v[176:179]
  v_mfma_f32_16x16x32_bf16 v[180:183], v[20:23], v[116:119], v[180:183]
  v_mfma_f32_16x16x32_bf16 v[184:187], v[20:23], v[120:123], v[184:187]
  v_mfma_f32_16x16x32_bf16 v[156:159], v[24:27], v[124:127], v[156:159]
  v_mfma_f32_16x16x32_bf16 v[160:163], v[24:27], v[128:131], v[160:163]
  v_mfma_f32_16x16x32_bf16 v[164:167], v[24:27], v[132:135], v[164:167]
  v_mfma_f32_16x16x32_bf16 v[168:171], v[24:27], v[136:139], v[168:171]
  v_mfma_f32_16x16x32_bf16 v[172:175], v[24:27], v[140:143], v[172:175]
  v_mfma_f32_16x16x32_bf16 v[176:179], v[24:27], v[144:147], v[176:179]
  v_mfma_f32_16x16x32_bf16 v[180:183], v[24:27], v[148:151], v[180:183]
  v_mfma_f32_16x16x32_bf16 v[184:187], v[24:27], v[152:155], v[184:187]
L_ysum:
  s_nop 1
  v_add_f32 v12, v156, v157
  v_add_f32 v13, v160, v161
  v_add_f32 v14, v164, v165
  v_add_f32 v15, v168, v169
  v_add_f32 v16, v172, v173
  v_add_f32 v17, v176, v177
  v_add_f32 v18, v180, v181
  v_add_f32 v19, v184, v185
  v_add_f32 v158, v158, v159
  v_add_f32 v162, v162, v163
  v_add_f32 v166, v166, v167
  v_add_f32 v170, v170, v171
  v_add_f32 v174, v174, v175
  v_add_f32 v178, v178, v179
  v_add_f32 v182, v182, v183
  v_add_f32 v186, v186, v187
  v_add_f32 v12, v12, v158
  v_add_f32 v13, v13, v162
  v_add_f32 v14, v14, v166
  v_add_f32 v15, v15, v170
  v_add_f32 v16, v16, v174
  v_add_f32 v17, v17, v178
  v_add_f32 v18, v18, v182
  v_add_f32 v19, v19, v186
  v_bfi_b32 v12, s79, v7, v12
  v_bfi_b32 v13, s79, v7, v13
  v_bfi_b32 v14, s79, v7, v14
  v_bfi_b32 v15, s79, v7, v15
  v_bfi_b32 v16, s79, v7, v16
  v_bfi_b32 v17, s79, v7, v17
  v_bfi_b32 v18, s79, v7, v18
  v_bfi_b32 v19, s79, v7, v19
  buffer_store_dwordx4 v[12:15], v9, s[64:67], s49 offen offset:0 sc1
  buffer_store_dwordx4 v[16:19], v9, s[64:67], s49 offen offset:256 sc1
L_hend:
  s_endpgm
L_w2:
  v_mul_u32_u24 v10, 36864, v5
  v_lshl_add_u32 v10, v6, 7, v10
  v_lshl_add_u32 v10, v2, 5, v10
  s_lshl_b32 s75, s44, 9
  s_add_u32 s72, s75, 28672
  s_add_u32 s73, s75, 176128
  s_add_u32 s74, s75, 34816
  s_add_u32 s75, s75, 182272
  v_cmp_eq_u32 s[82:83], 0, v6
  v_cmp_eq_u32 s[84:85], 1, v6
  v_cmp_eq_u32 s[86:87], 2, v6
  v_cmp_eq_u32 s[88:89], 3, v6
  v_mov_b32 v252, 148992
  s_mov_b32 s98, s99
L_w2w:
  ds_read_b32 v253, v252 offset:16
  s_waitcnt lgkmcnt(0)
  v_cmp_le_u32 vcc, 1, v253
  s_cbranch_vccnz L_w2wd
  s_sleep 32
  s_sub_u32 s98, s98, 1
  s_cmp_lg_u32 s98, 0
  s_cbranch_scc1 L_w2w
L_w2wd:
  s_mov_b64 s[96:97], -1
L_w2poll:
  s_mov_b64 exec, s[96:97]
  buffer_load_dwordx4 v[128:131], v10, s[64:67], s72 offen offset:0 sc1
  buffer_load_dwordx4 v[132:135], v10, s[64:67], s72 offen offset:16 sc1
  buffer_load_dwordx4 v[136:139], v10, s[64:67], s73 offen offset:0 sc1
  buffer_load_dwordx4 v[140:143], v10, s[64:67], s73 offen offset:16 sc1
  buffer_load_dwordx4 v[144:147], v10, s[64:67], s74 offen offset:0 sc1
  buffer_load_dwordx4 v[148:151], v10, s[64:67], s74 offen offset:16 sc1
  buffer_load_dwordx4 v[152:155], v10, s[64:67], s75 offen offset:0 sc1
  buffer_load_dwordx4 v[156:159], v10, s[64:67], s75 offen offset:16 sc1
L_w2chk:
  s_waitcnt vmcnt(0)
  v_cmpx_eq_u32_sdwa vcc, v7, v128 src0_sel:BYTE_0 src1_sel:BYTE_0
  v_cmpx_eq_u32_sdwa vcc, v7, v129 src0_sel:BYTE_0 src1_sel:BYTE_0
  v_cmpx_eq_u32_sdwa vcc, v7, v130 src0_sel:BYTE_0 src1_sel:BYTE_0
  v_cmpx_eq_u32_sdwa vcc, v7, v131 src0_sel:BYTE_0 src1_sel:BYTE_0
  v_cmpx_eq_u32_sdwa vcc, v7, v132 src0_sel:BYTE_0 src1_sel:BYTE_0
  v_cmpx_eq_u32_sdwa vcc, v7, v133 src0_sel:BYTE_0 src1_sel:BYTE_0
  v_cmpx_eq_u32_sdwa vcc, v7, v134 src0_sel:BYTE_0 src1_sel:BYTE_0
  v_cmpx_eq_u32_sdwa vcc, v7, v135 src0_sel:BYTE_0 src1_sel:BYTE_0
  v_cmpx_eq_u32_sdwa vcc, v7, v136 src0_sel:BYTE_0 src1_sel:BYTE_0
  v_cmpx_eq_u32_sdwa vcc, v7, v137 src0_sel:BYTE_0 src1_sel:BYTE_0
  v_cmpx_eq_u32_sdwa vcc, v7, v138 src0_sel:BYTE_0 src1_sel:BYTE_0
  v_cmpx_eq_u32_sdwa vcc, v7, v139 src0_sel:BYTE_0 src1_sel:BYTE_0
  v_cmpx_eq_u32_sdwa vcc, v7, v140 src0_sel:BYTE_0 src1_sel:BYTE_0
  v_cmpx_eq_u32_sdwa vcc, v7, v141 src0_sel:BYTE_0 src1_sel:BYTE_0
  v_cmpx_eq_u32_sdwa vcc, v7, v142 src0_sel:BYTE_0 src1_sel:BYTE_0
  v_cmpx_eq_u32_sdwa vcc, v7, v143 src0_sel:BYTE_0 src1_sel:BYTE_0
  v_cmpx_eq_u32_sdwa vcc, v7, v144 src0_sel:BYTE_0 src1_sel:BYTE_0
  v_cmpx_eq_u32_sdwa vcc, v7, v145 src0_sel:BYTE_0 src1_sel:BYTE_0
  v_cmpx_eq_u32_sdwa vcc, v7, v146 src0_sel:BYTE_0 src1_sel:BYTE_0
  v_cmpx_eq_u32_sdwa vcc, v7, v147 src0_sel:BYTE_0 src1_sel:BYTE_0
  v_cmpx_eq_u32_sdwa vcc, v7, v148 src0_sel:BYTE_0 src1_sel:BYTE_0
  v_cmpx_eq_u32_sdwa vcc, v7, v149 src0_sel:BYTE_0 src1_sel:BYTE_0
  v_cmpx_eq_u32_sdwa vcc, v7, v150 src0_sel:BYTE_0 src1_sel:BYTE_0
  v_cmpx_eq_u32_sdwa vcc, v7, v151 src0_sel:BYTE_0 src1_sel:BYTE_0
  v_cmpx_eq_u32_sdwa vcc, v7, v152 src0_sel:BYTE_0 src1_sel:BYTE_0
  v_cmpx_eq_u32_sdwa vcc, v7, v153 src0_sel:BYTE_0 src1_sel:BYTE_0
  v_cmpx_eq_u32_sdwa vcc, v7, v154 src0_sel:BYTE_0 src1_sel:BYTE_0
  v_cmpx_eq_u32_sdwa vcc, v7, v155 src0_sel:BYTE_0 src1_sel:BYTE_0
  v_cmpx_eq_u32_sdwa vcc, v7, v156 src0_sel:BYTE_0 src1_sel:BYTE_0
  v_cmpx_eq_u32_sdwa vcc, v7, v157 src0_sel:BYTE_0 src1_sel:BYTE_0
  v_cmpx_eq_u32_sdwa vcc, v7, v158 src0_sel:BYTE_0 src1_sel:BYTE_0
  v_cmpx_eq_u32_sdwa vcc, v7, v159 src0_sel:BYTE_0 src1_sel:BYTE_0
  s_nop 1
  s_andn2_b64 s[96:97], s[96:97], exec
  s_cbranch_scc0 L_w2go
  s_sleep 64
  s_sub_u32 s51, s51, 1
  s_cmp_lg_u32 s51, 0
  s_cbranch_scc1 L_w2poll
L_w2go:
  s_mov_b64 exec, -1
  s_nop 3
  v_and_b32 v128, 0xffffff00, v128
  v_and_b32 v129, 0xffffff00, v129
  v_and_b32 v130, 0xffffff00, v130
  v_and_b32 v131, 0xffffff00, v131
  v_and_b32 v132, 0xffffff00, v132
  v_and_b32 v133, 0xffffff00, v133
  v_and_b32 v134, 0xffffff00, v134
  v_and_b32 v135, 0xffffff00, v135
  v_and_b32 v136, 0xffffff00, v136
  v_and_b32 v137, 0xffffff00, v137
  v_and_b32 v138, 0xffffff00, v138
  v_and_b32 v139, 0xffffff00, v139
  v_and_b32 v140, 0xffffff00, v140
  v_and_b32 v141, 0xffffff00, v141
  v_and_b32 v142, 0xffffff00, v142
  v_and_b32 v143, 0xffffff00, v143
  v_and_b32 v144, 0xffffff00, v144
  v_and_b32 v145, 0xffffff00, v145
  v_and_b32 v146, 0xffffff00, v146
  v_and_b32 v147, 0xffffff00, v147
  v_and_b32 v148, 0xffffff00, v148
  v_and_b32 v149, 0xffffff00, v149
  v_and_b32 v150, 0xffffff00, v150
  v_and_b32 v151, 0xffffff00, v151
  v_and_b32 v152, 0xffffff00, v152
  v_and_b32 v153, 0xffffff00, v153
  v_and_b32 v154, 0xffffff00, v154
  v_and_b32 v155, 0xffffff00, v155
  v_and_b32 v156, 0xffffff00, v156
  v_and_b32 v157, 0xffffff00, v157
  v_and_b32 v158, 0xffffff00, v158
  v_and_b32 v159, 0xffffff00, v159
  v_add_f32 v128, v128, v136
  v_add_f32 v144, v144, v152
  v_cvt_pk_bf16_f32 v128, v128, v128
  v_and_b32 v128, 0xffff0000, v128
  v_cvt_pk_bf16_f32 v144, v144, v144
  v_and_b32 v144, 0xffff0000, v144
  v_mul_f32 v180, 0xbfb8aa3b, v128
  v_exp_f32 v180, v180
  s_nop 0
  v_add_f32 v180, 1.0, v180
  v_rcp_f32 v180, v180
  s_nop 0
  v_mul_f32 v180, v180, v128
  v_cvt_pk_bf16_f32 v180, v180, v180
  v_and_b32 v180, 0xffff0000, v180
  v_mul_f32 v180, v180, v144
  v_add_f32 v129, v129, v137
  v_add_f32 v145, v145, v153
  v_cvt_pk_bf16_f32 v129, v129, v129
  v_and_b32 v129, 0xffff0000, v129
  v_cvt_pk_bf16_f32 v145, v145, v145
  v_and_b32 v145, 0xffff0000, v145
  v_mul_f32 v181, 0xbfb8aa3b, v129
  v_exp_f32 v181, v181
  s_nop 0
  v_add_f32 v181, 1.0, v181
  v_rcp_f32 v181, v181
  s_nop 0
  v_mul_f32 v181, v181, v129
  v_cvt_pk_bf16_f32 v181, v181, v181
  v_and_b32 v181, 0xffff0000, v181
  v_mul_f32 v181, v181, v145
  v_add_f32 v130, v130, v138
  v_add_f32 v146, v146, v154
  v_cvt_pk_bf16_f32 v130, v130, v130
  v_and_b32 v130, 0xffff0000, v130
  v_cvt_pk_bf16_f32 v146, v146, v146
  v_and_b32 v146, 0xffff0000, v146
  v_mul_f32 v182, 0xbfb8aa3b, v130
  v_exp_f32 v182, v182
  s_nop 0
  v_add_f32 v182, 1.0, v182
  v_rcp_f32 v182, v182
  s_nop 0
  v_mul_f32 v182, v182, v130
  v_cvt_pk_bf16_f32 v182, v182, v182
  v_and_b32 v182, 0xffff0000, v182
  v_mul_f32 v182, v182, v146
  v_add_f32 v131, v131, v139
  v_add_f32 v147, v147, v155
  v_cvt_pk_bf16_f32 v131, v131, v131
  v_and_b32 v131, 0xffff0000, v131
  v_cvt_pk_bf16_f32 v147, v147, v147
  v_and_b32 v147, 0xffff0000, v147
  v_mul_f32 v183, 0xbfb8aa3b, v131
  v_exp_f32 v183, v183
  s_nop 0
  v_add_f32 v183, 1.0, v183
  v_rcp_f32 v183, v183
  s_nop 0
  v_mul_f32 v183, v183, v131
  v_cvt_pk_bf16_f32 v183, v183, v183
  v_and_b32 v183, 0xffff0000, v183
  v_mul_f32 v183, v183, v147
  v_add_f32 v132, v132, v140
  v_add_f32 v148, v148, v156
  v_cvt_pk_bf16_f32 v132, v132, v132
  v_and_b32 v132, 0xffff0000, v132
  v_cvt_pk_bf16_f32 v148, v148, v148
  v_and_b32 v148, 0xffff0000, v148
  v_mul_f32 v184, 0xbfb8aa3b, v132
  v_exp_f32 v184, v184
  s_nop 0
  v_add_f32 v184, 1.0, v184
  v_rcp_f32 v184, v184
  s_nop 0
  v_mul_f32 v184, v184, v132
  v_cvt_pk_bf16_f32 v184, v184, v184
  v_and_b32 v184, 0xffff0000, v184
  v_mul_f32 v184, v184, v148
  v_add_f32 v133, v133, v141
  v_add_f32 v149, v149, v157
  v_cvt_pk_bf16_f32 v133, v133, v133
  v_and_b32 v133, 0xffff0000, v133
  v_cvt_pk_bf16_f32 v149, v149, v149
  v_and_b32 v149, 0xffff0000, v149
  v_mul_f32 v185, 0xbfb8aa3b, v133
  v_exp_f32 v185, v185
  s_nop 0
  v_add_f32 v185, 1.0, v185
  v_rcp_f32 v185, v185
  s_nop 0
  v_mul_f32 v185, v185, v133
  v_cvt_pk_bf16_f32 v185, v185, v185
  v_and_b32 v185, 0xffff0000, v185
  v_mul_f32 v185, v185, v149
  v_add_f32 v134, v134, v142
  v_add_f32 v150, v150, v158
  v_cvt_pk_bf16_f32 v134, v134, v134
  v_and_b32 v134, 0xffff0000, v134
  v_cvt_pk_bf16_f32 v150, v150, v150
  v_and_b32 v150, 0xffff0000, v150
  v_mul_f32 v186, 0xbfb8aa3b, v134
  v_exp_f32 v186, v186
  s_nop 0
  v_add_f32 v186, 1.0, v186
  v_rcp_f32 v186, v186
  s_nop 0
  v_mul_f32 v186, v186, v134
  v_cvt_pk_bf16_f32 v186, v186, v186
  v_and_b32 v186, 0xffff0000, v186
  v_mul_f32 v186, v186, v150
  v_add_f32 v135, v135, v143
  v_add_f32 v151, v151, v159
  v_cvt_pk_bf16_f32 v135, v135, v135
  v_and_b32 v135, 0xffff0000, v135
  v_cvt_pk_bf16_f32 v151, v151, v151
  v_and_b32 v151, 0xffff0000, v151
  v_mul_f32 v187, 0xbfb8aa3b, v135
  v_exp_f32 v187, v187
  s_nop 0
  v_add_f32 v187, 1.0, v187
  v_rcp_f32 v187, v187
  s_nop 0
  v_mul_f32 v187, v187, v135
  v_cvt_pk_bf16_f32 v187, v187, v187
  v_and_b32 v187, 0xffff0000, v187
  v_mul_f32 v187, v187, v151
  v_cvt_pk_bf16_f32 v188, v180, v181
  v_cvt_pk_bf16_f32 v189, v182, v183
  v_cvt_pk_bf16_f32 v190, v184, v185
  v_cvt_pk_bf16_f32 v191, v186, v187
  v_cndmask_b32 v12, 0, v188, s[82:83]
  v_cndmask_b32 v13, 0, v189, s[82:83]
  v_cndmask_b32 v14, 0, v190, s[82:83]
  v_cndmask_b32 v15, 0, v191, s[82:83]
  v_cndmask_b32 v16, 0, v188, s[84:85]
  v_cndmask_b32 v17, 0, v189, s[84:85]
  v_cndmask_b32 v18, 0, v190, s[84:85]
  v_cndmask_b32 v19, 0, v191, s[84:85]
  v_cndmask_b32 v20, 0, v188, s[86:87]
  v_cndmask_b32 v21, 0, v189, s[86:87]
  v_cndmask_b32 v22, 0, v190, s[86:87]
  v_cndmask_b32 v23, 0, v191, s[86:87]
  v_cndmask_b32 v24, 0, v188, s[88:89]
  v_cndmask_b32 v25, 0, v189, s[88:89]
  v_cndmask_b32 v26, 0, v190, s[88:89]
  v_cndmask_b32 v27, 0, v191, s[88:89]
  s_branch L_tile
L_w2b:
  s_nop 1
  v_mfma_f32_16x16x32_bf16 v[156:159], v[12:15], v[28:31], 0
  v_mfma_f32_16x16x32_bf16 v[160:163], v[12:15], v[32:35], 0
  v_mfma_f32_16x16x32_bf16 v[164:167], v[12:15], v[36:39], 0
  v_mfma_f32_16x16x32_bf16 v[168:171], v[12:15], v[40:43], 0
  v_mfma_f32_16x16x32_bf16 v[172:175], v[12:15], v[44:47], 0
  v_mfma_f32_16x16x32_bf16 v[176:179], v[12:15], v[48:51], 0
  v_mfma_f32_16x16x32_bf16 v[180:183], v[12:15], v[52:55], 0
  v_mfma_f32_16x16x32_bf16 v[184:187], v[12:15], v[56:59], 0
  v_mfma_f32_16x16x32_bf16 v[156:159], v[16:19], v[60:63], v[156:159]
  v_mfma_f32_16x16x32_bf16 v[160:163], v[16:19], v[64:67], v[160:163]
  v_mfma_f32_16x16x32_bf16 v[164:167], v[16:19], v[68:71], v[164:167]
  v_mfma_f32_16x16x32_bf16 v[168:171], v[16:19], v[72:75], v[168:171]
  v_mfma_f32_16x16x32_bf16 v[172:175], v[16:19], v[76:79], v[172:175]
  v_mfma_f32_16x16x32_bf16 v[176:179], v[16:19], v[80:83], v[176:179]
  v_mfma_f32_16x16x32_bf16 v[180:183], v[16:19], v[84:87], v[180:183]
  v_mfma_f32_16x16x32_bf16 v[184:187], v[16:19], v[88:91], v[184:187]
  v_mfma_f32_16x16x32_bf16 v[156:159], v[20:23], v[92:95], v[156:159]
  v_mfma_f32_16x16x32_bf16 v[160:163], v[20:23], v[96:99], v[160:163]
  v_mfma_f32_16x16x32_bf16 v[164:167], v[20:23], v[100:103], v[164:167]
  v_mfma_f32_16x16x32_bf16 v[168:171], v[20:23], v[104:107], v[168:171]
  v_mfma_f32_16x16x32_bf16 v[172:175], v[20:23], v[108:111], v[172:175]
  v_mfma_f32_16x16x32_bf16 v[176:179], v[20:23], v[112:115], v[176:179]
  v_mfma_f32_16x16x32_bf16 v[180:183], v[20:23], v[116:119], v[180:183]
  v_mfma_f32_16x16x32_bf16 v[184:187], v[20:23], v[120:123], v[184:187]
  v_mfma_f32_16x16x32_bf16 v[156:159], v[24:27], v[124:127], v[156:159]
  v_mfma_f32_16x16x32_bf16 v[160:163], v[24:27], v[128:131], v[160:163]
  v_mfma_f32_16x16x32_bf16 v[164:167], v[24:27], v[132:135], v[164:167]
  v_mfma_f32_16x16x32_bf16 v[168:171], v[24:27], v[136:139], v[168:171]
  v_mfma_f32_16x16x32_bf16 v[172:175], v[24:27], v[140:143], v[172:175]
  v_mfma_f32_16x16x32_bf16 v[176:179], v[24:27], v[144:147], v[176:179]
  v_mfma_f32_16x16x32_bf16 v[180:183], v[24:27], v[148:151], v[180:183]
  v_mfma_f32_16x16x32_bf16 v[184:187], v[24:27], v[152:155], v[184:187]
  s_branch L_ysum
L_h1:
  s_mov_b32 s63, s2
  s_lshr_b32 s45, s63, 3
  s_mul_i32 s72, s45, 768
  s_add_u32 s72, s72, 4096
  s_add_u32 s73, s72, 147456
  s_add_u32 s74, s72, 36864
  s_add_u32 s75, s72, 184320
  s_add_u32 s76, s72, 73728
  s_add_u32 s77, s72, 221184
  s_add_u32 s78, s72, 110592
  s_add_u32 s79, s72, 258048
  v_lshlrev_b32 v9, 4, v0
  v_lshlrev_b32 v10, 3, v0
  v_add_u32 v10, 147456, v10
  v_mov_b32 v14, 148992
  v_mov_b32 v15, 1
  s_bfm_b64 s[80:81], 48, 0
  s_waitcnt lgkmcnt(0)
  s_add_u32 s42, s42, 1
  v_mov_b32 v8, s42
  s_movk_i32 s82, 0xff00
  v_mov_b32 v252, 148992
  s_mov_b32 s98, s99
L_qww:
  ds_read_b32 v253, v252 offset:24
  s_waitcnt lgkmcnt(0)
  v_cmp_le_u32 vcc, 1, v253
  s_cbranch_vccnz L_qwwd
  s_sleep 2
  s_sub_u32 s98, s98, 1
  s_cmp_lg_u32 s98, 0
  s_cbranch_scc1 L_qww
L_qwwd:
  s_mov_b64 s[96:97], s[80:81]
L_h1poll:
  s_mov_b64 exec, s[96:97]
  buffer_load_dwordx4 v[16:19], v9, s[64:67], s72 offen sc1
  buffer_load_dwordx4 v[20:23], v9, s[64:67], s73 offen sc1
L_h1chk:
  s_waitcnt vmcnt(0)
  v_cmpx_eq_u32_sdwa vcc, v8, v16 src0_sel:BYTE_0 src1_sel:BYTE_0
  v_cmpx_eq_u32_sdwa vcc, v8, v17 src0_sel:BYTE_0 src1_sel:BYTE_0
  v_cmpx_eq_u32_sdwa vcc, v8, v18 src0_sel:BYTE_0 src1_sel:BYTE_0
  v_cmpx_eq_u32_sdwa vcc, v8, v19 src0_sel:BYTE_0 src1_sel:BYTE_0
  v_cmpx_eq_u32_sdwa vcc, v8, v20 src0_sel:BYTE_0 src1_sel:BYTE_0
  v_cmpx_eq_u32_sdwa vcc, v8, v21 src0_sel:BYTE_0 src1_sel:BYTE_0
  v_cmpx_eq_u32_sdwa vcc, v8, v22 src0_sel:BYTE_0 src1_sel:BYTE_0
  v_cmpx_eq_u32_sdwa vcc, v8, v23 src0_sel:BYTE_0 src1_sel:BYTE_0
  s_nop 1
  s_andn2_b64 s[96:97], s[96:97], exec
  s_cbranch_scc0 L_h1go
  s_sleep 4
  s_sub_u32 s51, s51, 1
  s_cmp_lg_u32 s51, 0
  s_cbranch_scc1 L_h1poll
L_h1go:
  s_mov_b64 exec, s[80:81]
  s_nop 3
  v_and_b32 v16, s82, v16
  v_and_b32 v17, s82, v17
  v_and_b32 v18, s82, v18
  v_and_b32 v19, s82, v19
  v_and_b32 v20, s82, v20
  v_and_b32 v21, s82, v21
  v_and_b32 v22, s82, v22
  v_and_b32 v23, s82, v23
  v_add_f32 v16, v16, v20
  v_add_f32 v17, v17, v21
  v_add_f32 v18, v18, v22
  v_add_f32 v19, v19, v23
  v_cvt_pk_bf16_f32 v16, v16, v17
  v_cvt_pk_bf16_f32 v17, v18, v19
  ds_write_b64 v10, v[16:17] offset:0
  ds_write_b32 v14, v8 offset:12
  s_waitcnt lgkmcnt(0)
  ds_write_b32 v14, v15
  s_mov_b64 s[96:97], s[80:81]
L_h1bpoll:
  s_mov_b64 exec, s[96:97]
  buffer_load_dwordx4 v[24:27], v9, s[64:67], s74 offen sc1
  buffer_load_dwordx4 v[28:31], v9, s[64:67], s75 offen sc1
  buffer_load_dwordx4 v[32:35], v9, s[64:67], s76 offen sc1
  buffer_load_dwordx4 v[36:39], v9, s[64:67], s77 offen sc1
  buffer_load_dwordx4 v[40:43], v9, s[64:67], s78 offen sc1
  buffer_load_dwordx4 v[44:47], v9, s[64:67], s79 offen sc1
L_h1bchk:
  s_waitcnt vmcnt(0)
  v_cmpx_eq_u32_sdwa vcc, v8, v24 src0_sel:BYTE_0 src1_sel:BYTE_0
  v_cmpx_eq_u32_sdwa vcc, v8, v25 src0_sel:BYTE_0 src1_sel:BYTE_0
  v_cmpx_eq_u32_sdwa vcc, v8, v26 src0_sel:BYTE_0 src1_sel:BYTE_0
  v_cmpx_eq_u32_sdwa vcc, v8, v27 src0_sel:BYTE_0 src1_sel:BYTE_0
  v_cmpx_eq_u32_sdwa vcc, v8, v28 src0_sel:BYTE_0 src1_sel:BYTE_0
  v_cmpx_eq_u32_sdwa vcc, v8, v29 src0_sel:BYTE_0 src1_sel:BYTE_0
  v_cmpx_eq_u32_sdwa vcc, v8, v30 src0_sel:BYTE_0 src1_sel:BYTE_0
  v_cmpx_eq_u32_sdwa vcc, v8, v31 src0_sel:BYTE_0 src1_sel:BYTE_0
  v_cmpx_eq_u32_sdwa vcc, v8, v32 src0_sel:BYTE_0 src1_sel:BYTE_0
  v_cmpx_eq_u32_sdwa vcc, v8, v33 src0_sel:BYTE_0 src1_sel:BYTE_0
  v_cmpx_eq_u32_sdwa vcc, v8, v34 src0_sel:BYTE_0 src1_sel:BYTE_0
  v_cmpx_eq_u32_sdwa vcc, v8, v35 src0_sel:BYTE_0 src1_sel:BYTE_0
  v_cmpx_eq_u32_sdwa vcc, v8, v36 src0_sel:BYTE_0 src1_sel:BYTE_0
  v_cmpx_eq_u32_sdwa vcc, v8, v37 src0_sel:BYTE_0 src1_sel:BYTE_0
  v_cmpx_eq_u32_sdwa vcc, v8, v38 src0_sel:BYTE_0 src1_sel:BYTE_0
  v_cmpx_eq_u32_sdwa vcc, v8, v39 src0_sel:BYTE_0 src1_sel:BYTE_0
  v_cmpx_eq_u32_sdwa vcc, v8, v40 src0_sel:BYTE_0 src1_sel:BYTE_0
  v_cmpx_eq_u32_sdwa vcc, v8, v41 src0_sel:BYTE_0 src1_sel:BYTE_0
  v_cmpx_eq_u32_sdwa vcc, v8, v42 src0_sel:BYTE_0 src1_sel:BYTE_0
  v_cmpx_eq_u32_sdwa vcc, v8, v43 src0_sel:BYTE_0 src1_sel:BYTE_0
  v_cmpx_eq_u32_sdwa vcc, v8, v44 src0_sel:BYTE_0 src1_sel:BYTE_0
  v_cmpx_eq_u32_sdwa vcc, v8, v45 src0_sel:BYTE_0 src1_sel:BYTE_0
  v_cmpx_eq_u32_sdwa vcc, v8, v46 src0_sel:BYTE_0 src1_sel:BYTE_0
  v_cmpx_eq_u32_sdwa vcc, v8, v47 src0_sel:BYTE_0 src1_sel:BYTE_0
  s_nop 1
  s_andn2_b64 s[96:97], s[96:97], exec
  s_cbranch_scc0 L_h1bgo
  s_sleep 16
  s_sub_u32 s51, s51, 1
  s_cmp_lg_u32 s51, 0
  s_cbranch_scc1 L_h1bpoll
L_h1bgo:
  s_mov_b64 exec, s[80:81]
  s_nop 3
  v_and_b32 v24, s82, v24
  v_and_b32 v25, s82, v25
  v_and_b32 v26, s82, v26
  v_and_b32 v27, s82, v27
  v_and_b32 v28, s82, v28
  v_and_b32 v29, s82, v29
  v_and_b32 v30, s82, v30
  v_and_b32 v31, s82, v31
  v_add_f32 v24, v24, v28
  v_add_f32 v25, v25, v29
  v_add_f32 v26, v26, v30
  v_add_f32 v27, v27, v31
  v_cvt_pk_bf16_f32 v24, v24, v25
  v_cvt_pk_bf16_f32 v25, v26, v27
  ds_write_b64 v10, v[24:25] offset:384
  v_and_b32 v32, s82, v32
  v_and_b32 v33, s82, v33
  v_and_b32 v34, s82, v34
  v_and_b32 v35, s82, v35
  v_and_b32 v36, s82, v36
  v_and_b32 v37, s82, v37
  v_and_b32 v38, s82, v38
  v_and_b32 v39, s82, v39
  v_add_f32 v32, v32, v36
  v_add_f32 v33, v33, v37
  v_add_f32 v34, v34, v38
  v_add_f32 v35, v35, v39
  v_cvt_pk_bf16_f32 v32, v32, v33
  v_cvt_pk_bf16_f32 v33, v34, v35
  ds_write_b64 v10, v[32:33] offset:768
  v_and_b32 v40, s82, v40
  v_and_b32 v41, s82, v41
  v_and_b32 v42, s82, v42
  v_and_b32 v43, s82, v43
  v_and_b32 v44, s82, v44
  v_and_b32 v45, s82, v45
  v_and_b32 v46, s82, v46
  v_and_b32 v47, s82, v47
  v_add_f32 v40, v40, v44
  v_add_f32 v41, v41, v45
  v_add_f32 v42, v42, v46
  v_add_f32 v43, v43, v47
  v_cvt_pk_bf16_f32 v40, v40, v41
  v_cvt_pk_bf16_f32 v41, v42, v43
  ds_write_b64 v10, v[40:41] offset:1152
  v_mov_b32 v16, 2
  s_waitcnt lgkmcnt(0)
  ds_write_b32 v14, v16
  s_mov_b64 exec, -1
  v_mov_b32 v252, 148992
  s_mov_b32 s98, s99
L_mlw:
  ds_read_b32 v253, v252 offset:16
  s_waitcnt lgkmcnt(0)
  v_cmp_le_u32 vcc, 4, v253
  s_cbranch_vccnz L_mlwd
  s_sleep 32
  s_sub_u32 s98, s98, 1
  s_cmp_lg_u32 s98, 0
  s_cbranch_scc1 L_mlw
L_mlwd:
  v_lshlrev_b32 v10, 3, v1
  v_add_u32 v10, 149056, v10
  ds_read_b64 v[16:17], v10
  s_lshl_b32 s72, s63, 6
  s_add_u32 s72, s72, 311296
  s_lshl_b32 s73, s45, 9
  s_add_u32 s73, s73, 311296
  v_mov_b32 v21, s42
  v_mov_b32 v23, s42
  s_waitcnt lgkmcnt(0)
  v_mov_b32 v20, v16
  s_nop 1
  s_nop 1
  v_max_f32_dpp v20, v20, v20 row_ror:8 row_mask:0xf bank_mask:0xf
  s_nop 1
  v_max_f32_dpp v20, v20, v20 row_ror:4 row_mask:0xf bank_mask:0xf
  v_sub_f32 v22, v16, v20
  v_exp_f32 v22, v22
  s_nop 0
  v_mul_f32 v22, v22, v17
  s_nop 1
  s_nop 1
  v_add_f32_dpp v22, v22, v22 row_ror:8 row_mask:0xf bank_mask:0xf
  s_nop 1
  v_add_f32_dpp v22, v22, v22 row_ror:4 row_mask:0xf bank_mask:0xf
  s_mov_b64 exec, 15
  buffer_store_dwordx4 v[20:23], v9, s[64:67], s72 offen sc1
  s_mov_b64 exec, -1
  v_and_b32 v9, 0x1ff, v9
  v_mov_b32 v252, 148992
  s_mov_b32 s98, s99
L_m2w:
  ds_read_b32 v253, v252 offset:28
  s_waitcnt lgkmcnt(0)
  v_cmp_le_u32 vcc, 1, v253
  s_cbranch_vccnz L_m2wd
  s_sleep 32
  s_sub_u32 s98, s98, 1
  s_cmp_lg_u32 s98, 0
  s_cbranch_scc1 L_m2w
L_m2wd:
  s_mov_b64 s[96:97], -1
L_mlpoll:
  s_mov_b64 exec, s[96:97]
  buffer_load_dwordx4 v[24:27], v9, s[64:67], s73 offen sc1
L_mlchk:
  s_waitcnt vmcnt(0)
  v_cmpx_eq_u32 vcc, s42, v25
  v_cmpx_eq_u32 vcc, s42, v27
  s_nop 1
  s_andn2_b64 s[96:97], s[96:97], exec
  s_cbranch_scc0 L_mlgo
  s_sleep 32
  s_sub_u32 s51, s51, 1
  s_cmp_lg_u32 s51, 0
  s_cbranch_scc1 L_mlpoll
L_mlgo:
  s_mov_b64 exec, -1
  s_nop 3
  v_mov_b32 v28, v24
  s_nop 1
  s_nop 1
  v_max_f32_dpp v28, v28, v28 row_ror:8 row_mask:0xf bank_mask:0xf
  s_nop 1
  v_max_f32_dpp v28, v28, v28 row_ror:4 row_mask:0xf bank_mask:0xf
  v_mov_b32 v29, v28
  s_nop 1
  v_permlane16_swap_b32 v28, v29
  v_max_f32 v28, v28, v29
  v_sub_f32 v30, v24, v28
  v_exp_f32 v30, v30
  v_sub_f32 v31, v16, v28
  v_mul_f32 v30, v30, v26
  v_exp_f32 v31, v31
  s_nop 1
  s_nop 1
  v_add_f32_dpp v30, v30, v30 row_ror:8 row_mask:0xf bank_mask:0xf
  s_nop 1
  v_add_f32_dpp v30, v30, v30 row_ror:4 row_mask:0xf bank_mask:0xf
  v_mov_b32 v29, v30
  s_nop 1
  v_permlane16_swap_b32 v30, v29
  v_add_f32 v30, v30, v29
  v_rcp_f32 v30, v30
  v_lshlrev_b32 v10, 4, v6
  v_lshl_add_u32 v10, v5, 2, v10
  v_add_u32 v10, 149184, v10
  v_mul_f32 v31, v31, v30
  ds_write_b32 v10, v31
  s_waitcnt lgkmcnt(0)
  ds_write_b32 v14, v15 offset:20
  s_mov_b32 s70, 0
L_h1e:
  v_mov_b32 v252, 148992
  s_mov_b32 s98, s99
L_ew:
  ds_read_b32 v253, v252 offset:28
  s_waitcnt lgkmcnt(0)
  v_cmp_le_u32 vcc, 4, v253
  s_cbranch_vccnz L_ewd
  s_sleep 16
  s_sub_u32 s98, s98, 1
  s_cmp_lg_u32 s98, 0
  s_cbranch_scc1 L_ew
L_ewd:
  v_lshlrev_b32 v9, 4, v0
  v_add_u32 v10, 149504, v9
  s_mul_i32 s56, s63, 3072
  s_add_u32 s56, s56, 983040
  s_bfm_b64 exec, 48, 0
  ds_read_b128 v[16:19], v14 offset:192
  ds_read_b128 v[20:23], v10 offset:0
  ds_read_b128 v[24:27], v10 offset:3072
  ds_read_b128 v[28:31], v10 offset:6144
  ds_read_b128 v[32:35], v10 offset:9216
  s_waitcnt lgkmcnt(0)
  v_mul_f32 v36, v20, v16
  v_mul_f32 v37, v21, v16
  v_mul_f32 v38, v22, v16
  v_mul_f32 v39, v23, v16
  v_fmac_f32 v36, v24, v17
  v_fmac_f32 v37, v25, v17
  v_fmac_f32 v38, v26, v17
  v_fmac_f32 v39, v27, v17
  v_fmac_f32 v36, v28, v18
  v_fmac_f32 v37, v29, v18
  v_fmac_f32 v38, v30, v18
  v_fmac_f32 v39, v31, v18
  v_fmac_f32 v36, v32, v19
  v_fmac_f32 v37, v33, v19
  v_fmac_f32 v38, v34, v19
  v_fmac_f32 v39, v35, v19
  v_cvt_pk_bf16_f32 v40, v36, v37
  v_mov_b32 v41, s42
  v_cvt_pk_bf16_f32 v42, v38, v39
  v_mov_b32 v43, s42
  ds_read_b128 v[16:19], v14 offset:208
  ds_read_b128 v[20:23], v10 offset:768
  ds_read_b128 v[24:27], v10 offset:3840
  ds_read_b128 v[28:31], v10 offset:6912
  ds_read_b128 v[32:35], v10 offset:9984
  s_waitcnt lgkmcnt(0)
  v_mul_f32 v36, v20, v16
  v_mul_f32 v37, v21, v16
  v_mul_f32 v38, v22, v16
  v_mul_f32 v39, v23, v16
  v_fmac_f32 v36, v24, v17
  v_fmac_f32 v37, v25, v17
  v_fmac_f32 v38, v26, v17
  v_fmac_f32 v39, v27, v17
  v_fmac_f32 v36, v28, v18
  v_fmac_f32 v37, v29, v18
  v_fmac_f32 v38, v30, v18
  v_fmac_f32 v39, v31, v18
  v_fmac_f32 v36, v32, v19
  v_fmac_f32 v37, v33, v19
  v_fmac_f32 v38, v34, v19
  v_fmac_f32 v39, v35, v19
  v_cvt_pk_bf16_f32 v44, v36, v37
  v_mov_b32 v45, s42
  v_cvt_pk_bf16_f32 v46, v38, v39
  v_mov_b32 v47, s42
  ds_read_b128 v[16:19], v14 offset:224
  ds_read_b128 v[20:23], v10 offset:1536
  ds_read_b128 v[24:27], v10 offset:4608
  ds_read_b128 v[28:31], v10 offset:7680
  ds_read_b128 v[32:35], v10 offset:10752
  s_waitcnt lgkmcnt(0)
  v_mul_f32 v36, v20, v16
  v_mul_f32 v37, v21, v16
  v_mul_f32 v38, v22, v16
  v_mul_f32 v39, v23, v16
  v_fmac_f32 v36, v24, v17
  v_fmac_f32 v37, v25, v17
  v_fmac_f32 v38, v26, v17
  v_fmac_f32 v39, v27, v17
  v_fmac_f32 v36, v28, v18
  v_fmac_f32 v37, v29, v18
  v_fmac_f32 v38, v30, v18
  v_fmac_f32 v39, v31, v18
  v_fmac_f32 v36, v32, v19
  v_fmac_f32 v37, v33, v19
  v_fmac_f32 v38, v34, v19
  v_fmac_f32 v39, v35, v19
  v_cvt_pk_bf16_f32 v48, v36, v37
  v_mov_b32 v49, s42
  v_cvt_pk_bf16_f32 v50, v38, v39
  v_mov_b32 v51, s42
  v_mov_b32 v252, 148992
  s_mov_b32 s98, s99
L_e2w:
  ds_read_b32 v253, v252 offset:4
  s_waitcnt lgkmcnt(0)
  v_cmp_le_u32 vcc, 1, v253
  s_cbranch_vccnz L_e2wd
  s_sleep 2
  s_sub_u32 s98, s98, 1
  s_cmp_lg_u32 s98, 0
  s_cbranch_scc1 L_e2w
L_e2wd:
  buffer_store_dwordx4 v[40:43], v9, s[64:67], s56 offen offset:0 sc1
  buffer_store_dwordx4 v[44:47], v9, s[64:67], s56 offen offset:768 sc1
  buffer_store_dwordx4 v[48:51], v9, s[64:67], s56 offen offset:1536 sc1
  s_mov_b64 exec, -1
  s_cmp_ge_u32 s2, 240
  s_cbranch_scc1 L_h1x
  s_and_b32 s76, s2, 7
  s_mul_i32 s76, s76, 30
  s_lshr_b32 s77, s2, 3
  s_add_u32 s76, s76, s77
  s_mul_i32 s44, s76, 13108
  s_lshr_b32 s44, s44, 16
  s_lshl_b32 s46, s44, 1
  s_add_u32 s46, s46, 0
  s_mul_i32 s47, s46, 21846
  s_lshr_b32 s47, s47, 16
  s_mul_i32 s48, s47, 3
  s_sub_u32 s48, s46, s48
  s_mul_i32 s47, s47, 24576
  s_lshl_b32 s48, s48, 8
  s_add_u32 s47, s47, s48
  s_add_u32 s72, s47, 983040
  s_add_u32 s73, s47, 995328
  s_lshl_b32 s46, s44, 1
  s_add_u32 s46, s46, 1
  s_mul_i32 s47, s46, 21846
  s_lshr_b32 s47, s47, 16
  s_mul_i32 s48, s47, 3
  s_sub_u32 s48, s46, s48
  s_mul_i32 s47, s47, 24576
  s_lshl_b32 s48, s48, 8
  s_add_u32 s47, s47, s48
  s_add_u32 s74, s47, 983040
  s_add_u32 s75, s47, 995328
  v_lshl_add_u32 v11, v6, 2, v5
  v_mul_u32_u24 v11, 768, v11
  v_lshl_add_u32 v11, v2, 5, v11
  v_mul_u32_u24 v10, 12, v2
  v_add_u32 v10, v10, v1
  v_lshlrev_b32 v10, 4, v10
  v_add_u32 v10, 149504, v10
  s_mov_b32 s94, 0x0fff0fff
  s_mov_b32 s95, 0x0fff0fff
  s_mov_b32 s82, 0xffff0000
  v_mov_b32 v252, 148992
  s_mov_b32 s98, s99
L_gw:
  ds_read_b32 v253, v252 offset:8
  s_waitcnt lgkmcnt(0)
  v_cmp_le_u32 vcc, 1, v253
  s_cbranch_vccnz L_gwd
  s_sleep 2
  s_sub_u32 s98, s98, 1
  s_cmp_lg_u32 s98, 0
  s_cbranch_scc1 L_gw
L_gwd:
  s_mov_b64 s[96:97], s[94:95]
L_h1apoll:
  s_mov_b64 exec, s[96:97]
  buffer_load_dwordx4 v[64:67], v11, s[64:67], s72 offen offset:0 sc1
  buffer_load_dwordx4 v[68:71], v11, s[64:67], s72 offen offset:16 sc1
  buffer_load_dwordx4 v[72:75], v11, s[64:67], s73 offen offset:0 sc1
  buffer_load_dwordx4 v[76:79], v11, s[64:67], s73 offen offset:16 sc1
  buffer_load_dwordx4 v[80:83], v11, s[64:67], s72 offen offset:128 sc1
  buffer_load_dwordx4 v[84:87], v11, s[64:67], s72 offen offset:144 sc1
  buffer_load_dwordx4 v[88:91], v11, s[64:67], s73 offen offset:128 sc1
  buffer_load_dwordx4 v[92:95], v11, s[64:67], s73 offen offset:144 sc1
  buffer_load_dwordx4 v[96:99], v11, s[64:67], s74 offen offset:0 sc1
  buffer_load_dwordx4 v[100:103], v11, s[64:67], s74 offen offset:16 sc1
  buffer_load_dwordx4 v[104:107], v11, s[64:67], s75 offen offset:0 sc1
  buffer_load_dwordx4 v[108:111], v11, s[64:67], s75 offen offset:16 sc1
  buffer_load_dwordx4 v[112:115], v11, s[64:67], s74 offen offset:128 sc1
  buffer_load_dwordx4 v[116:119], v11, s[64:67], s74 offen offset:144 sc1
  buffer_load_dwordx4 v[120:123], v11, s[64:67], s75 offen offset:128 sc1
  buffer_load_dwordx4 v[124:127], v11, s[64:67], s75 offen offset:144 sc1
L_h1achk:
  s_waitcnt vmcnt(0)
  v_cmpx_eq_u32 vcc, s42, v65
  v_cmpx_eq_u32 vcc, s42, v67
  v_cmpx_eq_u32 vcc, s42, v69
  v_cmpx_eq_u32 vcc, s42, v71
  v_cmpx_eq_u32 vcc, s42, v73
  v_cmpx_eq_u32 vcc, s42, v75
  v_cmpx_eq_u32 vcc, s42, v77
  v_cmpx_eq_u32 vcc, s42, v79
  v_cmpx_eq_u32 vcc, s42, v81
  v_cmpx_eq_u32 vcc, s42, v83
  v_cmpx_eq_u32 vcc, s42, v85
  v_cmpx_eq_u32 vcc, s42, v87
  v_cmpx_eq_u32 vcc, s42, v89
  v_cmpx_eq_u32 vcc, s42, v91
  v_cmpx_eq_u32 vcc, s42, v93
  v_cmpx_eq_u32 vcc, s42, v95
  v_cmpx_eq_u32 vcc, s42, v97
  v_cmpx_eq_u32 vcc, s42, v99
  v_cmpx_eq_u32 vcc, s42, v101
  v_cmpx_eq_u32 vcc, s42, v103
  v_cmpx_eq_u32 vcc, s42, v105
  v_cmpx_eq_u32 vcc, s42, v107
  v_cmpx_eq_u32 vcc, s42, v109
  v_cmpx_eq_u32 vcc, s42, v111
  v_cmpx_eq_u32 vcc, s42, v113
  v_cmpx_eq_u32 vcc, s42, v115
  v_cmpx_eq_u32 vcc, s42, v117
  v_cmpx_eq_u32 vcc, s42, v119
  v_cmpx_eq_u32 vcc, s42, v121
  v_cmpx_eq_u32 vcc, s42, v123
  v_cmpx_eq_u32 vcc, s42, v125
  v_cmpx_eq_u32 vcc, s42, v127
  s_nop 1
  s_andn2_b64 s[96:97], s[96:97], exec
  s_cbranch_scc0 L_h1ago
  s_sleep 4
  s_sub_u32 s51, s51, 1
  s_cmp_lg_u32 s51, 0
  s_cbranch_scc1 L_h1apoll
L_h1ago:
  s_mov_b64 exec, s[94:95]
  s_nop 3
  v_lshlrev_b32 v65, 16, v64
  v_lshlrev_b32 v73, 16, v72
  v_and_b32 v64, s82, v64
  v_and_b32 v72, s82, v72
  v_add_f32 v65, v65, v73
  v_add_f32 v64, v64, v72
  v_cvt_pk_bf16_f32 v16, v65, v64
  v_lshlrev_b32 v67, 16, v66
  v_lshlrev_b32 v75, 16, v74
  v_and_b32 v66, s82, v66
  v_and_b32 v74, s82, v74
  v_add_f32 v67, v67, v75
  v_add_f32 v66, v66, v74
  v_cvt_pk_bf16_f32 v17, v67, v66
  v_lshlrev_b32 v69, 16, v68
  v_lshlrev_b32 v77, 16, v76
  v_and_b32 v68, s82, v68
  v_and_b32 v76, s82, v76
  v_add_f32 v69, v69, v77
  v_add_f32 v68, v68, v76
  v_cvt_pk_bf16_f32 v18, v69, v68
  v_lshlrev_b32 v71, 16, v70
  v_lshlrev_b32 v79, 16, v78
  v_and_b32 v70, s82, v70
  v_and_b32 v78, s82, v78
  v_add_f32 v71, v71, v79
  v_add_f32 v70, v70, v78
  v_cvt_pk_bf16_f32 v19, v71, v70
  v_lshlrev_b32 v81, 16, v80
  v_lshlrev_b32 v89, 16, v88
  v_and_b32 v80, s82, v80
  v_and_b32 v88, s82, v88
  v_add_f32 v81, v81, v89
  v_add_f32 v80, v80, v88
  v_cvt_pk_bf16_f32 v20, v81, v80
  v_lshlrev_b32 v83, 16, v82
  v_lshlrev_b32 v91, 16, v90
  v_and_b32 v82, s82, v82
  v_and_b32 v90, s82, v90
  v_add_f32 v83, v83, v91
  v_add_f32 v82, v82, v90
  v_cvt_pk_bf16_f32 v21, v83, v82
  v_lshlrev_b32 v85, 16, v84
  v_lshlrev_b32 v93, 16, v92
  v_and_b32 v84, s82, v84
  v_and_b32 v92, s82, v92
  v_add_f32 v85, v85, v93
  v_add_f32 v84, v84, v92
  v_cvt_pk_bf16_f32 v22, v85, v84
  v_lshlrev_b32 v87, 16, v86
  v_lshlrev_b32 v95, 16, v94
  v_and_b32 v86, s82, v86
  v_and_b32 v94, s82, v94
  v_add_f32 v87, v87, v95
  v_add_f32 v86, v86, v94
  v_cvt_pk_bf16_f32 v23, v87, v86
  v_lshlrev_b32 v97, 16, v96
  v_lshlrev_b32 v105, 16, v104
  v_and_b32 v96, s82, v96
  v_and_b32 v104, s82, v104
  v_add_f32 v97, v97, v105
  v_add_f32 v96, v96, v104
  v_cvt_pk_bf16_f32 v24, v97, v96
  v_lshlrev_b32 v99, 16, v98
  v_lshlrev_b32 v107, 16, v106
  v_and_b32 v98, s82, v98
  v_and_b32 v106, s82, v106
  v_add_f32 v99, v99, v107
  v_add_f32 v98, v98, v106
  v_cvt_pk_bf16_f32 v25, v99, v98
  v_lshlrev_b32 v101, 16, v100
  v_lshlrev_b32 v109, 16, v108
  v_and_b32 v100, s82, v100
  v_and_b32 v108, s82, v108
  v_add_f32 v101, v101, v109
  v_add_f32 v100, v100, v108
  v_cvt_pk_bf16_f32 v26, v101, v100
  v_lshlrev_b32 v103, 16, v102
  v_lshlrev_b32 v111, 16, v110
  v_and_b32 v102, s82, v102
  v_and_b32 v110, s82, v110
  v_add_f32 v103, v103, v111
  v_add_f32 v102, v102, v110
  v_cvt_pk_bf16_f32 v27, v103, v102
  v_lshlrev_b32 v113, 16, v112
  v_lshlrev_b32 v121, 16, v120
  v_and_b32 v112, s82, v112
  v_and_b32 v120, s82, v120
  v_add_f32 v113, v113, v121
  v_add_f32 v112, v112, v120
  v_cvt_pk_bf16_f32 v28, v113, v112
  v_lshlrev_b32 v115, 16, v114
  v_lshlrev_b32 v123, 16, v122
  v_and_b32 v114, s82, v114
  v_and_b32 v122, s82, v122
  v_add_f32 v115, v115, v123
  v_add_f32 v114, v114, v122
  v_cvt_pk_bf16_f32 v29, v115, v114
  v_lshlrev_b32 v117, 16, v116
  v_lshlrev_b32 v125, 16, v124
  v_and_b32 v116, s82, v116
  v_and_b32 v124, s82, v124
  v_add_f32 v117, v117, v125
  v_add_f32 v116, v116, v124
  v_cvt_pk_bf16_f32 v30, v117, v116
  v_lshlrev_b32 v119, 16, v118
  v_lshlrev_b32 v127, 16, v126
  v_and_b32 v118, s82, v118
  v_and_b32 v126, s82, v126
  v_add_f32 v119, v119, v127
  v_add_f32 v118, v118, v126
  v_cvt_pk_bf16_f32 v31, v119, v118
L_h1x:
  s_cmp_ge_u32 s2, 240
  s_cbranch_scc1 L_hend
  ds_write_b128 v10, v[16:19] offset:0
  ds_write_b128 v10, v[20:23] offset:3072
  ds_write_b128 v10, v[24:27] offset:6144
  ds_write_b128 v10, v[28:31] offset:9216
  s_waitcnt lgkmcnt(0)
  ds_write_b32 v14, v15 offset:32
  s_endpgm
L_stream2:
  v_add_u32 v17, s53, v11
  v_add_u32 v18, s53, v12
  ds_read_b128 v[48:51], v17 offset:0
  ds_read_b128 v[52:55], v18 offset:0
  ds_read_b128 v[56:59], v17 offset:128
  ds_read_b128 v[60:63], v18 offset:128
  ds_read_b128 v[64:67], v17 offset:256
  ds_read_b128 v[68:71], v18 offset:256
  s_add_u32 s62, s52, s53
  s_mov_b32 m0, s62
  s_waitcnt lgkmcnt(0)
  s_waitcnt vmcnt(4)
  buffer_load_dwordx4 v2, s[44:47], s54 offen offset:0 nt lds
  s_waitcnt vmcnt(5)
  buffer_load_dwordx4 v3, s[44:47], s54 offen offset:1024 nt lds
  s_waitcnt vmcnt(4)
  buffer_load_dwordx4 v4, s[44:47], s54 offen offset:2048 nt lds
  s_waitcnt vmcnt(5)
  buffer_load_dwordx4 v5, s[44:47], s54 offen offset:3072 nt lds
  s_add_u32 m0, s62, 4096
  s_waitcnt vmcnt(4)
  buffer_load_dwordx4 v6, s[44:47], s59 offen offset:0 nt lds
  s_waitcnt vmcnt(5)
  buffer_load_dwordx4 v7, s[44:47], s59 offen offset:1024 nt lds
  s_add_u32 s89, s89, 196608
  s_cmp_ge_u32 s89, 3145728
  s_cselect_b32 s57, 3145728, 0
  s_sub_u32 s89, s89, s57
  s_add_u32 s88, s88, 1
  s_and_b32 s57, s88, 15
  s_cselect_b32 s57, 0, 100663296
  s_add_u32 s73, s73, s57
  s_add_u32 s54, s73, s89
  s_add_u32 s59, s54, 4096
  s_add_u32 s53, s53, 6144
  s_cmp_ge_u32 s53, 36864
  s_cselect_b32 s53, 0, s53
  v_add_u32 v17, s53, v11
  v_add_u32 v18, s53, v12
  ds_read_b128 v[72:75], v17 offset:0
  ds_read_b128 v[76:79], v18 offset:0
  ds_read_b128 v[80:83], v17 offset:128
  ds_read_b128 v[84:87], v18 offset:128
  ds_read_b128 v[88:91], v17 offset:256
  ds_read_b128 v[92:95], v18 offset:256
  s_add_u32 s62, s52, s53
  s_mov_b32 m0, s62
  s_waitcnt lgkmcnt(0)
  s_waitcnt vmcnt(4)
  buffer_load_dwordx4 v2, s[44:47], s54 offen offset:0 nt lds
  s_waitcnt vmcnt(5)
  buffer_load_dwordx4 v3, s[44:47], s54 offen offset:1024 nt lds
  s_waitcnt vmcnt(4)
  buffer_load_dwordx4 v4, s[44:47], s54 offen offset:2048 nt lds
  s_waitcnt vmcnt(5)
  buffer_load_dwordx4 v5, s[44:47], s54 offen offset:3072 nt lds
  s_add_u32 m0, s62, 4096
  s_waitcnt vmcnt(4)
  buffer_load_dwordx4 v6, s[44:47], s59 offen offset:0 nt lds
  s_waitcnt vmcnt(5)
  buffer_load_dwordx4 v7, s[44:47], s59 offen offset:1024 nt lds
  s_add_u32 s89, s89, 196608
  s_cmp_ge_u32 s89, 3145728
  s_cselect_b32 s57, 3145728, 0
  s_sub_u32 s89, s89, s57
  s_add_u32 s88, s88, 1
  s_and_b32 s57, s88, 15
  s_cselect_b32 s57, 0, 100663296
  s_add_u32 s73, s73, s57
  s_add_u32 s54, s73, s89
  s_add_u32 s59, s54, 4096
  s_add_u32 s53, s53, 6144
  s_cmp_ge_u32 s53, 36864
  s_cselect_b32 s53, 0, s53
  v_mov_b32 v178, 148992
  s_mov_b32 s98, s99
L_stw:
  ds_read_b32 v179, v178 offset:0
  s_waitcnt lgkmcnt(0)
  v_cmp_le_u32 vcc, 1, v179
  s_cbranch_vccnz L_stwd
  s_sleep 1
  s_sub_u32 s98, s98, 1
  s_cmp_lg_u32 s98, 0
  s_cbranch_scc1 L_stw
L_stwd:
  ds_read_b128 v[24:27], v21 offset:0
  ds_read_b128 v[28:31], v21 offset:64
  ds_read_b128 v[32:35], v21 offset:128
  ds_read_b128 v[36:39], v21 offset:192
  ds_read_b128 v[40:43], v21 offset:256
  ds_read_b128 v[44:47], v21 offset:320
  ds_read_b32 v185, v178 offset:12
  s_waitcnt lgkmcnt(0)
  v_mfma_f32_16x16x32_bf16 v[144:147], v[48:51], v[24:27], 0
  v_mfma_f32_16x16x32_bf16 v[144:147], v[52:55], v[28:31], v[144:147]
  v_mfma_f32_16x16x32_bf16 v[144:147], v[56:59], v[32:35], v[144:147]
  v_mfma_f32_16x16x32_bf16 v[144:147], v[60:63], v[36:39], v[144:147]
  v_mfma_f32_16x16x32_bf16 v[144:147], v[64:67], v[40:43], v[144:147]
  v_mfma_f32_16x16x32_bf16 v[144:147], v[68:71], v[44:47], v[144:147]
  v_mfma_f32_16x16x32_bf16 v[148:151], v[72:75], v[24:27], 0
  v_mfma_f32_16x16x32_bf16 v[148:151], v[76:79], v[28:31], v[148:151]
  v_mfma_f32_16x16x32_bf16 v[148:151], v[80:83], v[32:35], v[148:151]
  v_mfma_f32_16x16x32_bf16 v[148:151], v[84:87], v[36:39], v[148:151]
  v_mfma_f32_16x16x32_bf16 v[148:151], v[88:91], v[40:43], v[148:151]
  v_mfma_f32_16x16x32_bf16 v[148:151], v[92:95], v[44:47], v[148:151]
  v_add_u32 v17, s53, v11
  v_add_u32 v18, s53, v12
  ds_read_b128 v[48:51], v17 offset:0
  ds_read_b128 v[52:55], v18 offset:0
  ds_read_b128 v[56:59], v17 offset:128
  ds_read_b128 v[60:63], v18 offset:128
  ds_read_b128 v[64:67], v17 offset:256
  ds_read_b128 v[68:71], v18 offset:256
  s_memrealtime s[76:77]
  v_mov_b32_dpp v148, v144 row_shr:1 row_mask:0xf bank_mask:0xf
  v_mov_b32_dpp v149, v145 row_shr:1 row_mask:0xf bank_mask:0xf
  v_mov_b32_dpp v150, v146 row_shr:1 row_mask:0xf bank_mask:0xf
  v_mov_b32_dpp v151, v147 row_shr:1 row_mask:0xf bank_mask:0xf
  s_mov_b32 s55, 28
  s_mov_b32 s58, 1
  s_waitcnt lgkmcnt(0)
  s_branch L_dispK
L_dispK:
  s_and_b32 s57, s58, 7
  s_cbranch_scc1 L_ngK
  v_mov_b32 v176, 148992
  s_mov_b32 s98, s99
L_q2w:
  ds_read_b32 v177, v176 offset:0
  s_waitcnt lgkmcnt(0)
  v_cmp_le_u32 vcc, 2, v177
  s_cbranch_vccnz L_q2wd
  s_sleep 1
  s_sub_u32 s98, s98, 1
  s_cmp_lg_u32 s98, 0
  s_cbranch_scc1 L_q2w
L_q2wd:
  v_add_u32 v21, 384, v21
  ds_read_b128 v[24:27], v21 offset:0
  ds_read_b128 v[28:31], v21 offset:64
  ds_read_b128 v[32:35], v21 offset:128
  ds_read_b128 v[36:39], v21 offset:192
  ds_read_b128 v[40:43], v21 offset:256
  ds_read_b128 v[44:47], v21 offset:320
  v_mov_b32 v152, v156
  v_mov_b32 v153, v157
  v_mov_b32 v154, v158
  v_mov_b32 v155, v159
  v_mov_b32 v156, v160
  v_mov_b32 v157, v161
  v_mov_b32 v158, v162
  v_mov_b32 v159, v163
  v_mov_b32 v160, v164
  v_mov_b32 v161, v165
  v_mov_b32 v162, v166
  v_mov_b32 v163, v167
  v_mov_b32 v164, v148
  v_mov_b32 v165, v149
  v_mov_b32 v166, v150
  v_mov_b32 v167, v151
  s_waitcnt lgkmcnt(0)
L_ngK:
  s_lshl_b32 s77, s76, 6
  s_mul_i32 s56, s79, s81
  s_sub_u32 s57, s77, s85
  s_mov_b32 s85, s77
  s_sub_u32 s57, s57, s56
  s_cmp_gt_i32 s57, 7680
  s_cselect_b32 s57, s57, 0
  s_add_u32 s86, s86, s57
  s_add_u32 s78, s78, s57
  s_add_u32 s78, s78, s56
  s_add_u32 s80, s80, s81
  s_sub_u32 s70, s77, s78
  s_bfe_u32 s57, s88, 0x50001
  s_sub_u32 s57, s57, s74
  s_cmp_lt_u32 s57, 12
  s_cselect_b32 s81, 5, 6
  s_cmp_eq_u32 s55, 0
  s_cbranch_scc1 L_outK
L_loopK:
  s_cmp_ge_u32 s80, s69
  s_cbranch_scc1 L_evK
L_retK:
  s_cmp_eq_u32 s81, 5
  s_cbranch_scc1 L_fastK
  s_cmp_gt_i32 s70, 7040
  s_cbranch_scc1 L_bK12
  s_cmp_gt_i32 s70, 1280
  s_cbranch_scc1 L_bK11
  s_cmp_gt_i32 s70, -960
  s_cbranch_scc1 L_bK10
  s_cmp_gt_i32 s70, -2880
  s_cbranch_scc1 L_bK9
  s_branch L_bK8
L_fastK:
  s_cmp_gt_i32 s70, 7040
  s_cbranch_scc1 L_bK16
  s_cmp_gt_i32 s70, 2880
  s_cbranch_scc1 L_bK14
  s_cmp_gt_i32 s70, 960
  s_cbranch_scc1 L_bK13
  s_cmp_gt_i32 s70, -960
  s_cbranch_scc1 L_bK12
  s_cmp_gt_i32 s70, -2880
  s_cbranch_scc1 L_bK11
  s_branch L_bK10
L_evK:
  s_cmp_eq_u32 s71, 1
  s_cbranch_scc1 L_ev1K
  s_cmp_eq_u32 s71, 2
  s_cbranch_scc1 L_ev2K
  s_sub_u32 s57, s80, s69
  s_mul_i32 s57, s57, s79
  s_sub_u32 s72, s77, s57
  s_mov_b32 s84, s69
  s_mov_b32 s87, s86
  s_mov_b32 s86, 0
  s_mov_b32 s71, 1
  s_add_u32 s69, s69, 11
  s_cmp_eq_u32 s68, 0
  s_cbranch_scc1 L_retK
  v_mov_b32 v184, s72
  s_mov_b64 exec, 1
  buffer_store_dwordx2 v[184:185], v182, s[64:67], s75 offen sc1
  s_mov_b64 exec, -1
  s_branch L_retK
L_ev1K:
  buffer_load_dwordx2 v[186:187], v183, s[64:67], s75 offen sc1
  s_mov_b32 s71, 2
  s_add_u32 s69, s80, 1
  s_add_u32 s75, s75, 512
  s_branch L_retK
L_ev2K:
  v_sub_u32 v186, s72, v186
  v_cmp_eq_u32 vcc, v185, v187
  v_cvt_f32_i32 v186, v186
  s_bcnt1_i32_b64 s57, vcc
  v_cndmask_b32 v186, 0, v186, vcc
  v_cvt_f32_u32 v188, s57
  s_nop 1
  s_nop 1
  v_add_f32_dpp v186, v186, v186 row_ror:8 row_mask:0xf bank_mask:0xf
  s_nop 1
  v_add_f32_dpp v186, v186, v186 row_ror:4 row_mask:0xf bank_mask:0xf
  s_nop 1
  v_add_f32_dpp v186, v186, v186 row_ror:2 row_mask:0xf bank_mask:0xf
  s_nop 1
  v_add_f32_dpp v186, v186, v186 row_ror:1 row_mask:0xf bank_mask:0xf
  v_mov_b32 v187, v186
  s_nop 1
  v_permlane32_swap_b32 v186, v187
  v_add_f32 v186, v186, v187
  v_mov_b32 v187, v186
  s_nop 1
  v_permlane16_swap_b32 v186, v187
  v_add_f32 v186, v186, v187
  v_max_f32 v188, 1.0, v188
  v_rcp_f32 v188, v188
  s_mov_b32 s71, 0
  s_add_u32 s69, s84, 60
  v_mul_f32 v186, v186, v188
  v_cvt_i32_f32 v187, v186
  s_nop 0
  v_readfirstlane_b32 s57, v187
  s_sub_u32 s57, s72, s57
  s_sub_u32 s82, s57, s83
  s_sub_u32 s82, s82, s87
  s_mov_b32 s83, s57
  s_mul_i32 s82, s82, 273
  s_lshr_b32 s82, s82, 14
  s_sub_u32 s82, s82, 7
  s_cmp_eq_u32 s84, 60
  s_cselect_b32 s79, s79, s82
  s_sub_u32 s78, s80, s84
  s_mul_i32 s78, s78, s79
  s_add_u32 s78, s78, s57
  s_add_u32 s78, s78, s86
  s_sub_u32 s70, s77, s78
  s_branch L_retK
L_bK8:
  s_add_u32 s62, s52, s53
  s_mov_b32 m0, s62
  s_waitcnt vmcnt(3)
  buffer_load_dwordx4 v2, s[44:47], s54 offen offset:0 nt lds
  v_mfma_f32_16x16x32_bf16 v[144:147], v[48:51], v[24:27], 0
  v_mfma_f32_16x16x32_bf16 v[144:147], v[52:55], v[28:31], v[144:147]
  v_mfma_f32_16x16x32_bf16 v[144:147], v[56:59], v[32:35], v[144:147]
  v_mfma_f32_16x16x32_bf16 v[144:147], v[60:63], v[36:39], v[144:147]
  v_mfma_f32_16x16x32_bf16 v[144:147], v[64:67], v[40:43], v[144:147]
  v_mfma_f32_16x16x32_bf16 v[144:147], v[68:71], v[44:47], v[144:147]
  s_waitcnt vmcnt(3)
  buffer_load_dwordx4 v3, s[44:47], s54 offen offset:1024 nt lds
  s_add_u32 s53, s53, 6144
  s_cmp_ge_u32 s53, 36864
  s_cselect_b32 s53, 0, s53
  v_add_u32 v17, s53, v11
  v_add_u32 v18, s53, v12
  ds_read_b128 v[72:75], v17 offset:0
  ds_read_b128 v[76:79], v18 offset:0
  ds_read_b128 v[80:83], v17 offset:128
  ds_read_b128 v[84:87], v18 offset:128
  ds_read_b128 v[88:91], v17 offset:256
  ds_read_b128 v[92:95], v18 offset:256
  s_waitcnt vmcnt(3)
  buffer_load_dwordx4 v4, s[44:47], s54 offen offset:2048 nt lds
  v_mov_b32_dpp v144, v148 row_shr:1 row_mask:0xf bank_mask:0xf
  v_mov_b32_dpp v145, v149 row_shr:1 row_mask:0xf bank_mask:0xf
  v_mov_b32_dpp v146, v150 row_shr:1 row_mask:0xf bank_mask:0xf
  v_mov_b32_dpp v147, v151 row_shr:1 row_mask:0xf bank_mask:0xf
  s_waitcnt vmcnt(3)
  buffer_load_dwordx4 v5, s[44:47], s54 offen offset:3072 nt lds
  s_add_u32 m0, s62, 4096
  s_waitcnt vmcnt(3)
  buffer_load_dwordx4 v6, s[44:47], s59 offen offset:0 nt lds
  s_waitcnt vmcnt(3)
  buffer_load_dwordx4 v7, s[44:47], s59 offen offset:1024 nt lds
  s_add_u32 s89, s89, 196608
  s_cmp_ge_u32 s89, 3145728
  s_cselect_b32 s57, 3145728, 0
  s_sub_u32 s89, s89, s57
  s_add_u32 s88, s88, 1
  s_and_b32 s57, s88, 15
  s_cselect_b32 s57, 0, 100663296
  s_add_u32 s73, s73, s57
  s_add_u32 s54, s73, s89
  s_add_u32 s59, s54, 4096
  s_waitcnt lgkmcnt(0)
L_oddK8:
  s_add_u32 s62, s52, s53
  s_mov_b32 m0, s62
  s_waitcnt vmcnt(3)
  buffer_load_dwordx4 v2, s[44:47], s54 offen offset:0 nt lds
  v_mfma_f32_16x16x32_bf16 v[148:151], v[72:75], v[24:27], 0
  v_mfma_f32_16x16x32_bf16 v[148:151], v[76:79], v[28:31], v[148:151]
  v_mfma_f32_16x16x32_bf16 v[148:151], v[80:83], v[32:35], v[148:151]
  v_mfma_f32_16x16x32_bf16 v[148:151], v[84:87], v[36:39], v[148:151]
  v_mfma_f32_16x16x32_bf16 v[148:151], v[88:91], v[40:43], v[148:151]
  v_mfma_f32_16x16x32_bf16 v[148:151], v[92:95], v[44:47], v[148:151]
  s_waitcnt vmcnt(3)
  buffer_load_dwordx4 v3, s[44:47], s54 offen offset:1024 nt lds
  s_add_u32 s53, s53, 6144
  s_cmp_ge_u32 s53, 36864
  s_cselect_b32 s53, 0, s53
  v_add_u32 v17, s53, v11
  v_add_u32 v18, s53, v12
  ds_read_b128 v[48:51], v17 offset:0
  ds_read_b128 v[52:55], v18 offset:0
  ds_read_b128 v[56:59], v17 offset:128
  ds_read_b128 v[60:63], v18 offset:128
  ds_read_b128 v[64:67], v17 offset:256
  ds_read_b128 v[68:71], v18 offset:256
  s_waitcnt vmcnt(3)
  buffer_load_dwordx4 v4, s[44:47], s54 offen offset:2048 nt lds
  v_mov_b32_dpp v148, v144 row_shr:1 row_mask:0xf bank_mask:0xf
  v_mov_b32_dpp v149, v145 row_shr:1 row_mask:0xf bank_mask:0xf
  v_mov_b32_dpp v150, v146 row_shr:1 row_mask:0xf bank_mask:0xf
  v_mov_b32_dpp v151, v147 row_shr:1 row_mask:0xf bank_mask:0xf
  s_waitcnt vmcnt(3)
  buffer_load_dwordx4 v5, s[44:47], s54 offen offset:3072 nt lds
  s_add_u32 m0, s62, 4096
  s_waitcnt vmcnt(3)
  buffer_load_dwordx4 v6, s[44:47], s59 offen offset:0 nt lds
  s_waitcnt vmcnt(3)
  buffer_load_dwordx4 v7, s[44:47], s59 offen offset:1024 nt lds
  s_add_u32 s89, s89, 196608
  s_cmp_ge_u32 s89, 3145728
  s_cselect_b32 s57, 3145728, 0
  s_sub_u32 s89, s89, s57
  s_add_u32 s88, s88, 1
  s_and_b32 s57, s88, 15
  s_cselect_b32 s57, 0, 100663296
  s_add_u32 s73, s73, s57
  s_add_u32 s54, s73, s89
  s_add_u32 s59, s54, 4096
  s_memrealtime s[76:77]
  s_waitcnt lgkmcnt(0)
  s_add_u32 s58, s58, 1
  s_sub_u32 s55, s55, 1
  s_branch L_dispK
L_bK9:
  s_add_u32 s62, s52, s53
  s_mov_b32 m0, s62
  s_waitcnt vmcnt(3)
  buffer_load_dwordx4 v2, s[44:47], s54 offen offset:0 nt lds
  v_mfma_f32_16x16x32_bf16 v[144:147], v[48:51], v[24:27], 0
  v_mfma_f32_16x16x32_bf16 v[144:147], v[52:55], v[28:31], v[144:147]
  v_mfma_f32_16x16x32_bf16 v[144:147], v[56:59], v[32:35], v[144:147]
  v_mfma_f32_16x16x32_bf16 v[144:147], v[60:63], v[36:39], v[144:147]
  v_mfma_f32_16x16x32_bf16 v[144:147], v[64:67], v[40:43], v[144:147]
  v_mfma_f32_16x16x32_bf16 v[144:147], v[68:71], v[44:47], v[144:147]
  s_waitcnt vmcnt(4)
  buffer_load_dwordx4 v3, s[44:47], s54 offen offset:1024 nt lds
  s_add_u32 s53, s53, 6144
  s_cmp_ge_u32 s53, 36864
  s_cselect_b32 s53, 0, s53
  v_add_u32 v17, s53, v11
  v_add_u32 v18, s53, v12
  ds_read_b128 v[72:75], v17 offset:0
  ds_read_b128 v[76:79], v18 offset:0
  ds_read_b128 v[80:83], v17 offset:128
  ds_read_b128 v[84:87], v18 offset:128
  ds_read_b128 v[88:91], v17 offset:256
  ds_read_b128 v[92:95], v18 offset:256
  s_waitcnt vmcnt(3)
  buffer_load_dwordx4 v4, s[44:47], s54 offen offset:2048 nt lds
  v_mov_b32_dpp v144, v148 row_shr:1 row_mask:0xf bank_mask:0xf
  v_mov_b32_dpp v145, v149 row_shr:1 row_mask:0xf bank_mask:0xf
  v_mov_b32_dpp v146, v150 row_shr:1 row_mask:0xf bank_mask:0xf
  v_mov_b32_dpp v147, v151 row_shr:1 row_mask:0xf bank_mask:0xf
  s_waitcnt vmcnt(4)
  buffer_load_dwordx4 v5, s[44:47], s54 offen offset:3072 nt lds
  s_add_u32 m0, s62, 4096
  s_waitcnt vmcnt(3)
  buffer_load_dwordx4 v6, s[44:47], s59 offen offset:0 nt lds
  s_waitcnt vmcnt(4)
  buffer_load_dwordx4 v7, s[44:47], s59 offen offset:1024 nt lds
  s_add_u32 s89, s89, 196608
  s_cmp_ge_u32 s89, 3145728
  s_cselect_b32 s57, 3145728, 0
  s_sub_u32 s89, s89, s57
  s_add_u32 s88, s88, 1
  s_and_b32 s57, s88, 15
  s_cselect_b32 s57, 0, 100663296
  s_add_u32 s73, s73, s57
  s_add_u32 s54, s73, s89
  s_add_u32 s59, s54, 4096
  s_waitcnt lgkmcnt(0)
L_oddK9:
  s_add_u32 s62, s52, s53
  s_mov_b32 m0, s62
  s_waitcnt vmcnt(3)
  buffer_load_dwordx4 v2, s[44:47], s54 offen offset:0 nt lds
  v_mfma_f32_16x16x32_bf16 v[148:151], v[72:75], v[24:27], 0
  v_mfma_f32_16x16x32_bf16 v[148:151], v[76:79], v[28:31], v[148:151]
  v_mfma_f32_16x16x32_bf16 v[148:151], v[80:83], v[32:35], v[148:151]
  v_mfma_f32_16x16x32_bf16 v[148:151], v[84:87], v[36:39], v[148:151]
  v_mfma_f32_16x16x32_bf16 v[148:151], v[88:91], v[40:43], v[148:151]
  v_mfma_f32_16x16x32_bf16 v[148:151], v[92:95], v[44:47], v[148:151]
  s_waitcnt vmcnt(4)
  buffer_load_dwordx4 v3, s[44:47], s54 offen offset:1024 nt lds
  s_add_u32 s53, s53, 6144
  s_cmp_ge_u32 s53, 36864
  s_cselect_b32 s53, 0, s53
  v_add_u32 v17, s53, v11
  v_add_u32 v18, s53, v12
  ds_read_b128 v[48:51], v17 offset:0
  ds_read_b128 v[52:55], v18 offset:0
  ds_read_b128 v[56:59], v17 offset:128
  ds_read_b128 v[60:63], v18 offset:128
  ds_read_b128 v[64:67], v17 offset:256
  ds_read_b128 v[68:71], v18 offset:256
  s_waitcnt vmcnt(3)
  buffer_load_dwordx4 v4, s[44:47], s54 offen offset:2048 nt lds
  v_mov_b32_dpp v148, v144 row_shr:1 row_mask:0xf bank_mask:0xf
  v_mov_b32_dpp v149, v145 row_shr:1 row_mask:0xf bank_mask:0xf
  v_mov_b32_dpp v150, v146 row_shr:1 row_mask:0xf bank_mask:0xf
  v_mov_b32_dpp v151, v147 row_shr:1 row_mask:0xf bank_mask:0xf
  s_waitcnt vmcnt(4)
  buffer_load_dwordx4 v5, s[44:47], s54 offen offset:3072 nt lds
  s_add_u32 m0, s62, 4096
  s_waitcnt vmcnt(3)
  buffer_load_dwordx4 v6, s[44:47], s59 offen offset:0 nt lds
  s_waitcnt vmcnt(4)
  buffer_load_dwordx4 v7, s[44:47], s59 offen offset:1024 nt lds
  s_add_u32 s89, s89, 196608
  s_cmp_ge_u32 s89, 3145728
  s_cselect_b32 s57, 3145728, 0
  s_sub_u32 s89, s89, s57
  s_add_u32 s88, s88, 1
  s_and_b32 s57, s88, 15
  s_cselect_b32 s57, 0, 100663296
  s_add_u32 s73, s73, s57
  s_add_u32 s54, s73, s89
  s_add_u32 s59, s54, 4096
  s_memrealtime s[76:77]
  s_waitcnt lgkmcnt(0)
  s_add_u32 s58, s58, 1
  s_sub_u32 s55, s55, 1
  s_branch L_dispK
L_bK10:
  s_add_u32 s62, s52, s53
  s_mov_b32 m0, s62
  s_waitcnt vmcnt(4)
  buffer_load_dwordx4 v2, s[44:47], s54 offen offset:0 nt lds
  v_mfma_f32_16x16x32_bf16 v[144:147], v[48:51], v[24:27], 0
  v_mfma_f32_16x16x32_bf16 v[144:147], v[52:55], v[28:31], v[144:147]
  v_mfma_f32_16x16x32_bf16 v[144:147], v[56:59], v[32:35], v[144:147]
  v_mfma_f32_16x16x32_bf16 v[144:147], v[60:63], v[36:39], v[144:147]
  v_mfma_f32_16x16x32_bf16 v[144:147], v[64:67], v[40:43], v[144:147]
  v_mfma_f32_16x16x32_bf16 v[144:147], v[68:71], v[44:47], v[144:147]
  s_waitcnt vmcnt(4)
  buffer_load_dwordx4 v3, s[44:47], s54 offen offset:1024 nt lds
  s_add_u32 s53, s53, 6144
  s_cmp_ge_u32 s53, 36864
  s_cselect_b32 s53, 0, s53
  v_add_u32 v17, s53, v11
  v_add_u32 v18, s53, v12
  ds_read_b128 v[72:75], v17 offset:0
  ds_read_b128 v[76:79], v18 offset:0
  ds_read_b128 v[80:83], v17 offset:128
  ds_read_b128 v[84:87], v18 offset:128
  ds_read_b128 v[88:91], v17 offset:256
  ds_read_b128 v[92:95], v18 offset:256
  s_waitcnt vmcnt(4)
  buffer_load_dwordx4 v4, s[44:47], s54 offen offset:2048 nt lds
  v_mov_b32_dpp v144, v148 row_shr:1 row_mask:0xf bank_mask:0xf
  v_mov_b32_dpp v145, v149 row_shr:1 row_mask:0xf bank_mask:0xf
  v_mov_b32_dpp v146, v150 row_shr:1 row_mask:0xf bank_mask:0xf
  v_mov_b32_dpp v147, v151 row_shr:1 row_mask:0xf bank_mask:0xf
  s_waitcnt vmcnt(4)
  buffer_load_dwordx4 v5, s[44:47], s54 offen offset:3072 nt lds
  s_add_u32 m0, s62, 4096
  s_waitcnt vmcnt(4)
  buffer_load_dwordx4 v6, s[44:47], s59 offen offset:0 nt lds
  s_waitcnt vmcnt(4)
  buffer_load_dwordx4 v7, s[44:47], s59 offen offset:1024 nt lds
  s_add_u32 s89, s89, 196608
  s_cmp_ge_u32 s89, 3145728
  s_cselect_b32 s57, 3145728, 0
  s_sub_u32 s89, s89, s57
  s_add_u32 s88, s88, 1
  s_and_b32 s57, s88, 15
  s_cselect_b32 s57, 0, 100663296
  s_add_u32 s73, s73, s57
  s_add_u32 s54, s73, s89
  s_add_u32 s59, s54, 4096
  s_waitcnt lgkmcnt(0)
L_oddK10:
  s_add_u32 s62, s52, s53
  s_mov_b32 m0, s62
  s_waitcnt vmcnt(4)
  buffer_load_dwordx4 v2, s[44:47], s54 offen offset:0 nt lds
  v_mfma_f32_16x16x32_bf16 v[148:151], v[72:75], v[24:27], 0
  v_mfma_f32_16x16x32_bf16 v[148:151], v[76:79], v[28:31], v[148:151]
  v_mfma_f32_16x16x32_bf16 v[148:151], v[80:83], v[32:35], v[148:151]
  v_mfma_f32_16x16x32_bf16 v[148:151], v[84:87], v[36:39], v[148:151]
  v_mfma_f32_16x16x32_bf16 v[148:151], v[88:91], v[40:43], v[148:151]
  v_mfma_f32_16x16x32_bf16 v[148:151], v[92:95], v[44:47], v[148:151]
  s_waitcnt vmcnt(4)
  buffer_load_dwordx4 v3, s[44:47], s54 offen offset:1024 nt lds
  s_add_u32 s53, s53, 6144
  s_cmp_ge_u32 s53, 36864
  s_cselect_b32 s53, 0, s53
  v_add_u32 v17, s53, v11
  v_add_u32 v18, s53, v12
  ds_read_b128 v[48:51], v17 offset:0
  ds_read_b128 v[52:55], v18 offset:0
  ds_read_b128 v[56:59], v17 offset:128
  ds_read_b128 v[60:63], v18 offset:128
  ds_read_b128 v[64:67], v17 offset:256
  ds_read_b128 v[68:71], v18 offset:256
  s_waitcnt vmcnt(4)
  buffer_load_dwordx4 v4, s[44:47], s54 offen offset:2048 nt lds
  v_mov_b32_dpp v148, v144 row_shr:1 row_mask:0xf bank_mask:0xf
  v_mov_b32_dpp v149, v145 row_shr:1 row_mask:0xf bank_mask:0xf
  v_mov_b32_dpp v150, v146 row_shr:1 row_mask:0xf bank_mask:0xf
  v_mov_b32_dpp v151, v147 row_shr:1 row_mask:0xf bank_mask:0xf
  s_waitcnt vmcnt(4)
  buffer_load_dwordx4 v5, s[44:47], s54 offen offset:3072 nt lds
  s_add_u32 m0, s62, 4096
  s_waitcnt vmcnt(4)
  buffer_load_dwordx4 v6, s[44:47], s59 offen offset:0 nt lds
  s_waitcnt vmcnt(4)
  buffer_load_dwordx4 v7, s[44:47], s59 offen offset:1024 nt lds
  s_add_u32 s89, s89, 196608
  s_cmp_ge_u32 s89, 3145728
  s_cselect_b32 s57, 3145728, 0
  s_sub_u32 s89, s89, s57
  s_add_u32 s88, s88, 1
  s_and_b32 s57, s88, 15
  s_cselect_b32 s57, 0, 100663296
  s_add_u32 s73, s73, s57
  s_add_u32 s54, s73, s89
  s_add_u32 s59, s54, 4096
  s_memrealtime s[76:77]
  s_waitcnt lgkmcnt(0)
  s_add_u32 s58, s58, 1
  s_sub_u32 s55, s55, 1
  s_branch L_dispK
L_bK11:
  s_add_u32 s62, s52, s53
  s_mov_b32 m0, s62
  s_waitcnt vmcnt(4)
  buffer_load_dwordx4 v2, s[44:47], s54 offen offset:0 nt lds
  v_mfma_f32_16x16x32_bf16 v[144:147], v[48:51], v[24:27], 0
  v_mfma_f32_16x16x32_bf16 v[144:147], v[52:55], v[28:31], v[144:147]
  v_mfma_f32_16x16x32_bf16 v[144:147], v[56:59], v[32:35], v[144:147]
  v_mfma_f32_16x16x32_bf16 v[144:147], v[60:63], v[36:39], v[144:147]
  v_mfma_f32_16x16x32_bf16 v[144:147], v[64:67], v[40:43], v[144:147]
  v_mfma_f32_16x16x32_bf16 v[144:147], v[68:71], v[44:47], v[144:147]
  s_waitcnt vmcnt(5)
  buffer_load_dwordx4 v3, s[44:47], s54 offen offset:1024 nt lds
  s_add_u32 s53, s53, 6144
  s_cmp_ge_u32 s53, 36864
  s_cselect_b32 s53, 0, s53
  v_add_u32 v17, s53, v11
  v_add_u32 v18, s53, v12
  ds_read_b128 v[72:75], v17 offset:0
  ds_read_b128 v[76:79], v18 offset:0
  ds_read_b128 v[80:83], v17 offset:128
  ds_read_b128 v[84:87], v18 offset:128
  ds_read_b128 v[88:91], v17 offset:256
  ds_read_b128 v[92:95], v18 offset:256
  s_waitcnt vmcnt(4)
  buffer_load_dwordx4 v4, s[44:47], s54 offen offset:2048 nt lds
  v_mov_b32_dpp v144, v148 row_shr:1 row_mask:0xf bank_mask:0xf
  v_mov_b32_dpp v145, v149 row_shr:1 row_mask:0xf bank_mask:0xf
  v_mov_b32_dpp v146, v150 row_shr:1 row_mask:0xf bank_mask:0xf
  v_mov_b32_dpp v147, v151 row_shr:1 row_mask:0xf bank_mask:0xf
  s_waitcnt vmcnt(5)
  buffer_load_dwordx4 v5, s[44:47], s54 offen offset:3072 nt lds
  s_add_u32 m0, s62, 4096
  s_waitcnt vmcnt(4)
  buffer_load_dwordx4 v6, s[44:47], s59 offen offset:0 nt lds
  s_waitcnt vmcnt(5)
  buffer_load_dwordx4 v7, s[44:47], s59 offen offset:1024 nt lds
  s_add_u32 s89, s89, 196608
  s_cmp_ge_u32 s89, 3145728
  s_cselect_b32 s57, 3145728, 0
  s_sub_u32 s89, s89, s57
  s_add_u32 s88, s88, 1
  s_and_b32 s57, s88, 15
  s_cselect_b32 s57, 0, 100663296
  s_add_u32 s73, s73, s57
  s_add_u32 s54, s73, s89
  s_add_u32 s59, s54, 4096
  s_waitcnt lgkmcnt(0)
L_oddK11:
  s_add_u32 s62, s52, s53
  s_mov_b32 m0, s62
  s_waitcnt vmcnt(4)
  buffer_load_dwordx4 v2, s[44:47], s54 offen offset:0 nt lds
  v_mfma_f32_16x16x32_bf16 v[148:151], v[72:75], v[24:27], 0
  v_mfma_f32_16x16x32_bf16 v[148:151], v[76:79], v[28:31], v[148:151]
  v_mfma_f32_16x16x32_bf16 v[148:151], v[80:83], v[32:35], v[148:151]
  v_mfma_f32_16x16x32_bf16 v[148:151], v[84:87], v[36:39], v[148:151]
  v_mfma_f32_16x16x32_bf16 v[148:151], v[88:91], v[40:43], v[148:151]
  v_mfma_f32_16x16x32_bf16 v[148:151], v[92:95], v[44:47], v[148:151]
  s_waitcnt vmcnt(5)
  buffer_load_dwordx4 v3, s[44:47], s54 offen offset:1024 nt lds
  s_add_u32 s53, s53, 6144
  s_cmp_ge_u32 s53, 36864
  s_cselect_b32 s53, 0, s53
  v_add_u32 v17, s53, v11
  v_add_u32 v18, s53, v12
  ds_read_b128 v[48:51], v17 offset:0
  ds_read_b128 v[52:55], v18 offset:0
  ds_read_b128 v[56:59], v17 offset:128
  ds_read_b128 v[60:63], v18 offset:128
  ds_read_b128 v[64:67], v17 offset:256
  ds_read_b128 v[68:71], v18 offset:256
  s_waitcnt vmcnt(4)
  buffer_load_dwordx4 v4, s[44:47], s54 offen offset:2048 nt lds
  v_mov_b32_dpp v148, v144 row_shr:1 row_mask:0xf bank_mask:0xf
  v_mov_b32_dpp v149, v145 row_shr:1 row_mask:0xf bank_mask:0xf
  v_mov_b32_dpp v150, v146 row_shr:1 row_mask:0xf bank_mask:0xf
  v_mov_b32_dpp v151, v147 row_shr:1 row_mask:0xf bank_mask:0xf
  s_waitcnt vmcnt(5)
  buffer_load_dwordx4 v5, s[44:47], s54 offen offset:3072 nt lds
  s_add_u32 m0, s62, 4096
  s_waitcnt vmcnt(4)
  buffer_load_dwordx4 v6, s[44:47], s59 offen offset:0 nt lds
  s_waitcnt vmcnt(5)
  buffer_load_dwordx4 v7, s[44:47], s59 offen offset:1024 nt lds
  s_add_u32 s89, s89, 196608
  s_cmp_ge_u32 s89, 3145728
  s_cselect_b32 s57, 3145728, 0
  s_sub_u32 s89, s89, s57
  s_add_u32 s88, s88, 1
  s_and_b32 s57, s88, 15
  s_cselect_b32 s57, 0, 100663296
  s_add_u32 s73, s73, s57
  s_add_u32 s54, s73, s89
  s_add_u32 s59, s54, 4096
  s_memrealtime s[76:77]
  s_waitcnt lgkmcnt(0)
  s_add_u32 s58, s58, 1
  s_sub_u32 s55, s55, 1
  s_branch L_dispK
L_bK12:
  s_add_u32 s62, s52, s53
  s_mov_b32 m0, s62
  s_waitcnt vmcnt(5)
  buffer_load_dwordx4 v2, s[44:47], s54 offen offset:0 nt lds
  v_mfma_f32_16x16x32_bf16 v[144:147], v[48:51], v[24:27], 0
  v_mfma_f32_16x16x32_bf16 v[144:147], v[52:55], v[28:31], v[144:147]
  v_mfma_f32_16x16x32_bf16 v[144:147], v[56:59], v[32:35], v[144:147]
  v_mfma_f32_16x16x32_bf16 v[144:147], v[60:63], v[36:39], v[144:147]
  v_mfma_f32_16x16x32_bf16 v[144:147], v[64:67], v[40:43], v[144:147]
  v_mfma_f32_16x16x32_bf16 v[144:147], v[68:71], v[44:47], v[144:147]
  s_waitcnt vmcnt(5)
  buffer_load_dwordx4 v3, s[44:47], s54 offen offset:1024 nt lds
  s_add_u32 s53, s53, 6144
  s_cmp_ge_u32 s53, 36864
  s_cselect_b32 s53, 0, s53
  v_add_u32 v17, s53, v11
  v_add_u32 v18, s53, v12
  ds_read_b128 v[72:75], v17 offset:0
  ds_read_b128 v[76:79], v18 offset:0
  ds_read_b128 v[80:83], v17 offset:128
  ds_read_b128 v[84:87], v18 offset:128
  ds_read_b128 v[88:91], v17 offset:256
  ds_read_b128 v[92:95], v18 offset:256
  s_waitcnt vmcnt(5)
  buffer_load_dwordx4 v4, s[44:47], s54 offen offset:2048 nt lds
  v_mov_b32_dpp v144, v148 row_shr:1 row_mask:0xf bank_mask:0xf
  v_mov_b32_dpp v145, v149 row_shr:1 row_mask:0xf bank_mask:0xf
  v_mov_b32_dpp v146, v150 row_shr:1 row_mask:0xf bank_mask:0xf
  v_mov_b32_dpp v147, v151 row_shr:1 row_mask:0xf bank_mask:0xf
  s_waitcnt vmcnt(5)
  buffer_load_dwordx4 v5, s[44:47], s54 offen offset:3072 nt lds
  s_add_u32 m0, s62, 4096
  s_waitcnt vmcnt(5)
  buffer_load_dwordx4 v6, s[44:47], s59 offen offset:0 nt lds
  s_waitcnt vmcnt(5)
  buffer_load_dwordx4 v7, s[44:47], s59 offen offset:1024 nt lds
  s_add_u32 s89, s89, 196608
  s_cmp_ge_u32 s89, 3145728
  s_cselect_b32 s57, 3145728, 0
  s_sub_u32 s89, s89, s57
  s_add_u32 s88, s88, 1
  s_and_b32 s57, s88, 15
  s_cselect_b32 s57, 0, 100663296
  s_add_u32 s73, s73, s57
  s_add_u32 s54, s73, s89
  s_add_u32 s59, s54, 4096
  s_waitcnt lgkmcnt(0)
L_oddK12:
  s_add_u32 s62, s52, s53
  s_mov_b32 m0, s62
  s_waitcnt vmcnt(5)
  buffer_load_dwordx4 v2, s[44:47], s54 offen offset:0 nt lds
  v_mfma_f32_16x16x32_bf16 v[148:151], v[72:75], v[24:27], 0
  v_mfma_f32_16x16x32_bf16 v[148:151], v[76:79], v[28:31], v[148:151]
  v_mfma_f32_16x16x32_bf16 v[148:151], v[80:83], v[32:35], v[148:151]
  v_mfma_f32_16x16x32_bf16 v[148:151], v[84:87], v[36:39], v[148:151]
  v_mfma_f32_16x16x32_bf16 v[148:151], v[88:91], v[40:43], v[148:151]
  v_mfma_f32_16x16x32_bf16 v[148:151], v[92:95], v[44:47], v[148:151]
  s_waitcnt vmcnt(5)
  buffer_load_dwordx4 v3, s[44:47], s54 offen offset:1024 nt lds
  s_add_u32 s53, s53, 6144
  s_cmp_ge_u32 s53, 36864
  s_cselect_b32 s53, 0, s53
  v_add_u32 v17, s53, v11
  v_add_u32 v18, s53, v12
  ds_read_b128 v[48:51], v17 offset:0
  ds_read_b128 v[52:55], v18 offset:0
  ds_read_b128 v[56:59], v17 offset:128
  ds_read_b128 v[60:63], v18 offset:128
  ds_read_b128 v[64:67], v17 offset:256
  ds_read_b128 v[68:71], v18 offset:256
  s_waitcnt vmcnt(5)
  buffer_load_dwordx4 v4, s[44:47], s54 offen offset:2048 nt lds
  v_mov_b32_dpp v148, v144 row_shr:1 row_mask:0xf bank_mask:0xf
  v_mov_b32_dpp v149, v145 row_shr:1 row_mask:0xf bank_mask:0xf
  v_mov_b32_dpp v150, v146 row_shr:1 row_mask:0xf bank_mask:0xf
  v_mov_b32_dpp v151, v147 row_shr:1 row_mask:0xf bank_mask:0xf
  s_waitcnt vmcnt(5)
  buffer_load_dwordx4 v5, s[44:47], s54 offen offset:3072 nt lds
  s_add_u32 m0, s62, 4096
  s_waitcnt vmcnt(5)
  buffer_load_dwordx4 v6, s[44:47], s59 offen offset:0 nt lds
  s_waitcnt vmcnt(5)
  buffer_load_dwordx4 v7, s[44:47], s59 offen offset:1024 nt lds
  s_add_u32 s89, s89, 196608
  s_cmp_ge_u32 s89, 3145728
  s_cselect_b32 s57, 3145728, 0
  s_sub_u32 s89, s89, s57
  s_add_u32 s88, s88, 1
  s_and_b32 s57, s88, 15
  s_cselect_b32 s57, 0, 100663296
  s_add_u32 s73, s73, s57
  s_add_u32 s54, s73, s89
  s_add_u32 s59, s54, 4096
  s_memrealtime s[76:77]
  s_waitcnt lgkmcnt(0)
  s_add_u32 s58, s58, 1
  s_sub_u32 s55, s55, 1
  s_branch L_dispK
L_bK13:
  s_add_u32 s62, s52, s53
  s_mov_b32 m0, s62
  s_waitcnt vmcnt(5)
  buffer_load_dwordx4 v2, s[44:47], s54 offen offset:0 nt lds
  v_mfma_f32_16x16x32_bf16 v[144:147], v[48:51], v[24:27], 0
  v_mfma_f32_16x16x32_bf16 v[144:147], v[52:55], v[28:31], v[144:147]
  v_mfma_f32_16x16x32_bf16 v[144:147], v[56:59], v[32:35], v[144:147]
  v_mfma_f32_16x16x32_bf16 v[144:147], v[60:63], v[36:39], v[144:147]
  v_mfma_f32_16x16x32_bf16 v[144:147], v[64:67], v[40:43], v[144:147]
  v_mfma_f32_16x16x32_bf16 v[144:147], v[68:71], v[44:47], v[144:147]
  s_waitcnt vmcnt(6)
  buffer_load_dwordx4 v3, s[44:47], s54 offen offset:1024 nt lds
  s_add_u32 s53, s53, 6144
  s_cmp_ge_u32 s53, 36864
  s_cselect_b32 s53, 0, s53
  v_add_u32 v17, s53, v11
  v_add_u32 v18, s53, v12
  ds_read_b128 v[72:75], v17 offset:0
  ds_read_b128 v[76:79], v18 offset:0
  ds_read_b128 v[80:83], v17 offset:128
  ds_read_b128 v[84:87], v18 offset:128
  ds_read_b128 v[88:91], v17 offset:256
  ds_read_b128 v[92:95], v18 offset:256
  s_waitcnt vmcnt(5)
  buffer_load_dwordx4 v4, s[44:47], s54 offen offset:2048 nt lds
  v_mov_b32_dpp v144, v148 row_shr:1 row_mask:0xf bank_mask:0xf
  v_mov_b32_dpp v145, v149 row_shr:1 row_mask:0xf bank_mask:0xf
  v_mov_b32_dpp v146, v150 row_shr:1 row_mask:0xf bank_mask:0xf
  v_mov_b32_dpp v147, v151 row_shr:1 row_mask:0xf bank_mask:0xf
  s_waitcnt vmcnt(6)
  buffer_load_dwordx4 v5, s[44:47], s54 offen offset:3072 nt lds
  s_add_u32 m0, s62, 4096
  s_waitcnt vmcnt(5)
  buffer_load_dwordx4 v6, s[44:47], s59 offen offset:0 nt lds
  s_waitcnt vmcnt(6)
  buffer_load_dwordx4 v7, s[44:47], s59 offen offset:1024 nt lds
  s_add_u32 s89, s89, 196608
  s_cmp_ge_u32 s89, 3145728
  s_cselect_b32 s57, 3145728, 0
  s_sub_u32 s89, s89, s57
  s_add_u32 s88, s88, 1
  s_and_b32 s57, s88, 15
  s_cselect_b32 s57, 0, 100663296
  s_add_u32 s73, s73, s57
  s_add_u32 s54, s73, s89
  s_add_u32 s59, s54, 4096
  s_waitcnt lgkmcnt(0)
L_oddK13:
  s_add_u32 s62, s52, s53
  s_mov_b32 m0, s62
  s_waitcnt vmcnt(5)
  buffer_load_dwordx4 v2, s[44:47], s54 offen offset:0 nt lds
  v_mfma_f32_16x16x32_bf16 v[148:151], v[72:75], v[24:27], 0
  v_mfma_f32_16x16x32_bf16 v[148:151], v[76:79], v[28:31], v[148:151]
  v_mfma_f32_16x16x32_bf16 v[148:151], v[80:83], v[32:35], v[148:151]
  v_mfma_f32_16x16x32_bf16 v[148:151], v[84:87], v[36:39], v[148:151]
  v_mfma_f32_16x16x32_bf16 v[148:151], v[88:91], v[40:43], v[148:151]
  v_mfma_f32_16x16x32_bf16 v[148:151], v[92:95], v[44:47], v[148:151]
  s_waitcnt vmcnt(6)
  buffer_load_dwordx4 v3, s[44:47], s54 offen offset:1024 nt lds
  s_add_u32 s53, s53, 6144
  s_cmp_ge_u32 s53, 36864
  s_cselect_b32 s53, 0, s53
  v_add_u32 v17, s53, v11
  v_add_u32 v18, s53, v12
  ds_read_b128 v[48:51], v17 offset:0
  ds_read_b128 v[52:55], v18 offset:0
  ds_read_b128 v[56:59], v17 offset:128
  ds_read_b128 v[60:63], v18 offset:128
  ds_read_b128 v[64:67], v17 offset:256
  ds_read_b128 v[68:71], v18 offset:256
  s_waitcnt vmcnt(5)
  buffer_load_dwordx4 v4, s[44:47], s54 offen offset:2048 nt lds
  v_mov_b32_dpp v148, v144 row_shr:1 row_mask:0xf bank_mask:0xf
  v_mov_b32_dpp v149, v145 row_shr:1 row_mask:0xf bank_mask:0xf
  v_mov_b32_dpp v150, v146 row_shr:1 row_mask:0xf bank_mask:0xf
  v_mov_b32_dpp v151, v147 row_shr:1 row_mask:0xf bank_mask:0xf
  s_waitcnt vmcnt(6)
  buffer_load_dwordx4 v5, s[44:47], s54 offen offset:3072 nt lds
  s_add_u32 m0, s62, 4096
  s_waitcnt vmcnt(5)
  buffer_load_dwordx4 v6, s[44:47], s59 offen offset:0 nt lds
  s_waitcnt vmcnt(6)
  buffer_load_dwordx4 v7, s[44:47], s59 offen offset:1024 nt lds
  s_add_u32 s89, s89, 196608
  s_cmp_ge_u32 s89, 3145728
  s_cselect_b32 s57, 3145728, 0
  s_sub_u32 s89, s89, s57
  s_add_u32 s88, s88, 1
  s_and_b32 s57, s88, 15
  s_cselect_b32 s57, 0, 100663296
  s_add_u32 s73, s73, s57
  s_add_u32 s54, s73, s89
  s_add_u32 s59, s54, 4096
  s_memrealtime s[76:77]
  s_waitcnt lgkmcnt(0)
  s_add_u32 s58, s58, 1
  s_sub_u32 s55, s55, 1
  s_branch L_dispK
L_bK14:
  s_add_u32 s62, s52, s53
  s_mov_b32 m0, s62
  s_waitcnt vmcnt(6)
  buffer_load_dwordx4 v2, s[44:47], s54 offen offset:0 nt lds
  v_mfma_f32_16x16x32_bf16 v[144:147], v[48:51], v[24:27], 0
  v_mfma_f32_16x16x32_bf16 v[144:147], v[52:55], v[28:31], v[144:147]
  v_mfma_f32_16x16x32_bf16 v[144:147], v[56:59], v[32:35], v[144:147]
  v_mfma_f32_16x16x32_bf16 v[144:147], v[60:63], v[36:39], v[144:147]
  v_mfma_f32_16x16x32_bf16 v[144:147], v[64:67], v[40:43], v[144:147]
  v_mfma_f32_16x16x32_bf16 v[144:147], v[68:71], v[44:47], v[144:147]
  s_waitcnt vmcnt(6)
  buffer_load_dwordx4 v3, s[44:47], s54 offen offset:1024 nt lds
  s_add_u32 s53, s53, 6144
  s_cmp_ge_u32 s53, 36864
  s_cselect_b32 s53, 0, s53
  v_add_u32 v17, s53, v11
  v_add_u32 v18, s53, v12
  ds_read_b128 v[72:75], v17 offset:0
  ds_read_b128 v[76:79], v18 offset:0
  ds_read_b128 v[80:83], v17 offset:128
  ds_read_b128 v[84:87], v18 offset:128
  ds_read_b128 v[88:91], v17 offset:256
  ds_read_b128 v[92:95], v18 offset:256
  s_waitcnt vmcnt(6)
  buffer_load_dwordx4 v4, s[44:47], s54 offen offset:2048 nt lds
  v_mov_b32_dpp v144, v148 row_shr:1 row_mask:0xf bank_mask:0xf
  v_mov_b32_dpp v145, v149 row_shr:1 row_mask:0xf bank_mask:0xf
  v_mov_b32_dpp v146, v150 row_shr:1 row_mask:0xf bank_mask:0xf
  v_mov_b32_dpp v147, v151 row_shr:1 row_mask:0xf bank_mask:0xf
  s_waitcnt vmcnt(6)
  buffer_load_dwordx4 v5, s[44:47], s54 offen offset:3072 nt lds
  s_add_u32 m0, s62, 4096
  s_waitcnt vmcnt(6)
  buffer_load_dwordx4 v6, s[44:47], s59 offen offset:0 nt lds
  s_waitcnt vmcnt(6)
  buffer_load_dwordx4 v7, s[44:47], s59 offen offset:1024 nt lds
  s_add_u32 s89, s89, 196608
  s_cmp_ge_u32 s89, 3145728
  s_cselect_b32 s57, 3145728, 0
  s_sub_u32 s89, s89, s57
  s_add_u32 s88, s88, 1
  s_and_b32 s57, s88, 15
  s_cselect_b32 s57, 0, 100663296
  s_add_u32 s73, s73, s57
  s_add_u32 s54, s73, s89
  s_add_u32 s59, s54, 4096
  s_waitcnt lgkmcnt(0)
L_oddK14:
  s_add_u32 s62, s52, s53
  s_mov_b32 m0, s62
  s_waitcnt vmcnt(6)
  buffer_load_dwordx4 v2, s[44:47], s54 offen offset:0 nt lds
  v_mfma_f32_16x16x32_bf16 v[148:151], v[72:75], v[24:27], 0
  v_mfma_f32_16x16x32_bf16 v[148:151], v[76:79], v[28:31], v[148:151]
  v_mfma_f32_16x16x32_bf16 v[148:151], v[80:83], v[32:35], v[148:151]
  v_mfma_f32_16x16x32_bf16 v[148:151], v[84:87], v[36:39], v[148:151]
  v_mfma_f32_16x16x32_bf16 v[148:151], v[88:91], v[40:43], v[148:151]
  v_mfma_f32_16x16x32_bf16 v[148:151], v[92:95], v[44:47], v[148:151]
  s_waitcnt vmcnt(6)
  buffer_load_dwordx4 v3, s[44:47], s54 offen offset:1024 nt lds
  s_add_u32 s53, s53, 6144
  s_cmp_ge_u32 s53, 36864
  s_cselect_b32 s53, 0, s53
  v_add_u32 v17, s53, v11
  v_add_u32 v18, s53, v12
  ds_read_b128 v[48:51], v17 offset:0
  ds_read_b128 v[52:55], v18 offset:0
  ds_read_b128 v[56:59], v17 offset:128
  ds_read_b128 v[60:63], v18 offset:128
  ds_read_b128 v[64:67], v17 offset:256
  ds_read_b128 v[68:71], v18 offset:256
  s_waitcnt vmcnt(6)
  buffer_load_dwordx4 v4, s[44:47], s54 offen offset:2048 nt lds
  v_mov_b32_dpp v148, v144 row_shr:1 row_mask:0xf bank_mask:0xf
  v_mov_b32_dpp v149, v145 row_shr:1 row_mask:0xf bank_mask:0xf
  v_mov_b32_dpp v150, v146 row_shr:1 row_mask:0xf bank_mask:0xf
  v_mov_b32_dpp v151, v147 row_shr:1 row_mask:0xf bank_mask:0xf
  s_waitcnt vmcnt(6)
  buffer_load_dwordx4 v5, s[44:47], s54 offen offset:3072 nt lds
  s_add_u32 m0, s62, 4096
  s_waitcnt vmcnt(6)
  buffer_load_dwordx4 v6, s[44:47], s59 offen offset:0 nt lds
  s_waitcnt vmcnt(6)
  buffer_load_dwordx4 v7, s[44:47], s59 offen offset:1024 nt lds
  s_add_u32 s89, s89, 196608
  s_cmp_ge_u32 s89, 3145728
  s_cselect_b32 s57, 3145728, 0
  s_sub_u32 s89, s89, s57
  s_add_u32 s88, s88, 1
  s_and_b32 s57, s88, 15
  s_cselect_b32 s57, 0, 100663296
  s_add_u32 s73, s73, s57
  s_add_u32 s54, s73, s89
  s_add_u32 s59, s54, 4096
  s_memrealtime s[76:77]
  s_waitcnt lgkmcnt(0)
  s_add_u32 s58, s58, 1
  s_sub_u32 s55, s55, 1
  s_branch L_dispK
L_bK16:
  s_add_u32 s62, s52, s53
  s_mov_b32 m0, s62
  s_waitcnt vmcnt(7)
  buffer_load_dwordx4 v2, s[44:47], s54 offen offset:0 nt lds
  v_mfma_f32_16x16x32_bf16 v[144:147], v[48:51], v[24:27], 0
  v_mfma_f32_16x16x32_bf16 v[144:147], v[52:55], v[28:31], v[144:147]
  v_mfma_f32_16x16x32_bf16 v[144:147], v[56:59], v[32:35], v[144:147]
  v_mfma_f32_16x16x32_bf16 v[144:147], v[60:63], v[36:39], v[144:147]
  v_mfma_f32_16x16x32_bf16 v[144:147], v[64:67], v[40:43], v[144:147]
  v_mfma_f32_16x16x32_bf16 v[144:147], v[68:71], v[44:47], v[144:147]
  s_waitcnt vmcnt(7)
  buffer_load_dwordx4 v3, s[44:47], s54 offen offset:1024 nt lds
  s_add_u32 s53, s53, 6144
  s_cmp_ge_u32 s53, 36864
  s_cselect_b32 s53, 0, s53
  v_add_u32 v17, s53, v11
  v_add_u32 v18, s53, v12
  ds_read_b128 v[72:75], v17 offset:0
  ds_read_b128 v[76:79], v18 offset:0
  ds_read_b128 v[80:83], v17 offset:128
  ds_read_b128 v[84:87], v18 offset:128
  ds_read_b128 v[88:91], v17 offset:256
  ds_read_b128 v[92:95], v18 offset:256
  s_waitcnt vmcnt(7)
  buffer_load_dwordx4 v4, s[44:47], s54 offen offset:2048 nt lds
  v_mov_b32_dpp v144, v148 row_shr:1 row_mask:0xf bank_mask:0xf
  v_mov_b32_dpp v145, v149 row_shr:1 row_mask:0xf bank_mask:0xf
  v_mov_b32_dpp v146, v150 row_shr:1 row_mask:0xf bank_mask:0xf
  v_mov_b32_dpp v147, v151 row_shr:1 row_mask:0xf bank_mask:0xf
  s_waitcnt vmcnt(7)
  buffer_load_dwordx4 v5, s[44:47], s54 offen offset:3072 nt lds
  s_add_u32 m0, s62, 4096
  s_waitcnt vmcnt(7)
  buffer_load_dwordx4 v6, s[44:47], s59 offen offset:0 nt lds
  s_waitcnt vmcnt(7)
  buffer_load_dwordx4 v7, s[44:47], s59 offen offset:1024 nt lds
  s_add_u32 s89, s89, 196608
  s_cmp_ge_u32 s89, 3145728
  s_cselect_b32 s57, 3145728, 0
  s_sub_u32 s89, s89, s57
  s_add_u32 s88, s88, 1
  s_and_b32 s57, s88, 15
  s_cselect_b32 s57, 0, 100663296
  s_add_u32 s73, s73, s57
  s_add_u32 s54, s73, s89
  s_add_u32 s59, s54, 4096
  s_waitcnt lgkmcnt(0)
L_oddK16:
  s_add_u32 s62, s52, s53
  s_mov_b32 m0, s62
  s_waitcnt vmcnt(7)
  buffer_load_dwordx4 v2, s[44:47], s54 offen offset:0 nt lds
  v_mfma_f32_16x16x32_bf16 v[148:151], v[72:75], v[24:27], 0
  v_mfma_f32_16x16x32_bf16 v[148:151], v[76:79], v[28:31], v[148:151]
  v_mfma_f32_16x16x32_bf16 v[148:151], v[80:83], v[32:35], v[148:151]
  v_mfma_f32_16x16x32_bf16 v[148:151], v[84:87], v[36:39], v[148:151]
  v_mfma_f32_16x16x32_bf16 v[148:151], v[88:91], v[40:43], v[148:151]
  v_mfma_f32_16x16x32_bf16 v[148:151], v[92:95], v[44:47], v[148:151]
  s_waitcnt vmcnt(7)
  buffer_load_dwordx4 v3, s[44:47], s54 offen offset:1024 nt lds
  s_add_u32 s53, s53, 6144
  s_cmp_ge_u32 s53, 36864
  s_cselect_b32 s53, 0, s53
  v_add_u32 v17, s53, v11
  v_add_u32 v18, s53, v12
  ds_read_b128 v[48:51], v17 offset:0
  ds_read_b128 v[52:55], v18 offset:0
  ds_read_b128 v[56:59], v17 offset:128
  ds_read_b128 v[60:63], v18 offset:128
  ds_read_b128 v[64:67], v17 offset:256
  ds_read_b128 v[68:71], v18 offset:256
  s_waitcnt vmcnt(7)
  buffer_load_dwordx4 v4, s[44:47], s54 offen offset:2048 nt lds
  v_mov_b32_dpp v148, v144 row_shr:1 row_mask:0xf bank_mask:0xf
  v_mov_b32_dpp v149, v145 row_shr:1 row_mask:0xf bank_mask:0xf
  v_mov_b32_dpp v150, v146 row_shr:1 row_mask:0xf bank_mask:0xf
  v_mov_b32_dpp v151, v147 row_shr:1 row_mask:0xf bank_mask:0xf
  s_waitcnt vmcnt(7)
  buffer_load_dwordx4 v5, s[44:47], s54 offen offset:3072 nt lds
  s_add_u32 m0, s62, 4096
  s_waitcnt vmcnt(7)
  buffer_load_dwordx4 v6, s[44:47], s59 offen offset:0 nt lds
  s_waitcnt vmcnt(7)
  buffer_load_dwordx4 v7, s[44:47], s59 offen offset:1024 nt lds
  s_add_u32 s89, s89, 196608
  s_cmp_ge_u32 s89, 3145728
  s_cselect_b32 s57, 3145728, 0
  s_sub_u32 s89, s89, s57
  s_add_u32 s88, s88, 1
  s_and_b32 s57, s88, 15
  s_cselect_b32 s57, 0, 100663296
  s_add_u32 s73, s73, s57
  s_add_u32 s54, s73, s89
  s_add_u32 s59, s54, 4096
  s_memrealtime s[76:77]
  s_waitcnt lgkmcnt(0)
  s_add_u32 s58, s58, 1
  s_sub_u32 s55, s55, 1
  s_branch L_dispK
L_outK:
  s_cmp_eq_u32 s58, 32
  s_cbranch_scc1 L_mid
  s_mov_b32 s44, s48
  s_mov_b32 s45, s49
  s_mov_b32 s73, 0
  s_mov_b32 s54, s89
  s_add_u32 s59, s54, 4096
  v_mov_b32 v2, v8
  v_mov_b32 v3, v9
  v_mov_b32 v4, v10
  v_mov_b32 v5, v8
  v_mov_b32 v6, v9
  v_mov_b32 v7, v10
  s_mov_b32 s55, 3
  s_branch L_loopK
L_mid:
  v_add_u32 v17, s53, v13
  v_add_u32 v18, s53, v14
  v_add_u32 v19, s53, v15
  v_add_u32 v20, s53, v16
  ds_read_b64_tr_b16 v[48:49], v17 offset:0
  ds_read_b64_tr_b16 v[50:51], v18 offset:0
  ds_read_b64_tr_b16 v[52:53], v19 offset:0
  ds_read_b64_tr_b16 v[54:55], v20 offset:0
  ds_read_b64_tr_b16 v[56:57], v17 offset:128
  ds_read_b64_tr_b16 v[58:59], v18 offset:128
  ds_read_b64_tr_b16 v[60:61], v19 offset:128
  ds_read_b64_tr_b16 v[62:63], v20 offset:128
  ds_read_b64_tr_b16 v[64:65], v17 offset:256
  ds_read_b64_tr_b16 v[66:67], v18 offset:256
  ds_read_b64_tr_b16 v[68:69], v19 offset:256
  ds_read_b64_tr_b16 v[70:71], v20 offset:256
  s_mov_b32 s57, 0xffff0000
  s_mov_b32 s56, 0x3d93cd3a
  v_cvt_pk_bf16_f32 v153, v152, v153
  v_cvt_pk_bf16_f32 v155, v154, v155
  v_cvt_pk_bf16_f32 v157, v156, v157
  v_cvt_pk_bf16_f32 v159, v158, v159
  v_cvt_pk_bf16_f32 v161, v160, v161
  v_cvt_pk_bf16_f32 v163, v162, v163
  v_cvt_pk_bf16_f32 v165, v164, v165
  v_cvt_pk_bf16_f32 v167, v166, v167
  v_lshlrev_b32 v152, 16, v153
  v_and_b32 v153, s57, v153
  v_lshlrev_b32 v154, 16, v155
  v_and_b32 v155, s57, v155
  v_lshlrev_b32 v156, 16, v157
  v_and_b32 v157, s57, v157
  v_lshlrev_b32 v158, 16, v159
  v_and_b32 v159, s57, v159
  v_lshlrev_b32 v160, 16, v161
  v_and_b32 v161, s57, v161
  v_lshlrev_b32 v162, 16, v163
  v_and_b32 v163, s57, v163
  v_lshlrev_b32 v164, 16, v165
  v_and_b32 v165, s57, v165
  v_lshlrev_b32 v166, 16, v167
  v_and_b32 v167, s57, v167
  s_add_u32 s62, s52, s53
  s_mov_b32 m0, s62
  s_waitcnt lgkmcnt(0)
  s_waitcnt vmcnt(4)
  buffer_load_dwordx4 v2, s[44:47], s54 offen offset:0 nt lds
  v_mul_f32 v152, s56, v152
  v_mul_f32 v153, s56, v153
  v_mul_f32 v154, s56, v154
  v_mul_f32 v155, s56, v155
  v_mul_f32 v156, s56, v156
  v_mul_f32 v157, s56, v157
  v_mul_f32 v158, s56, v158
  v_mul_f32 v159, s56, v159
  v_mul_f32 v160, s56, v160
  v_mul_f32 v161, s56, v161
  v_mul_f32 v162, s56, v162
  v_mul_f32 v163, s56, v163
  v_mul_f32 v164, s56, v164
  v_mul_f32 v165, s56, v165
  v_mul_f32 v166, s56, v166
  v_mul_f32 v167, s56, v167
  v_cvt_pk_bf16_f32 v153, v152, v153
  v_cvt_pk_bf16_f32 v155, v154, v155
  v_cvt_pk_bf16_f32 v157, v156, v157
  v_cvt_pk_bf16_f32 v159, v158, v159
  v_cvt_pk_bf16_f32 v161, v160, v161
  v_cvt_pk_bf16_f32 v163, v162, v163
  v_cvt_pk_bf16_f32 v165, v164, v165
  v_cvt_pk_bf16_f32 v167, v166, v167
  v_lshlrev_b32 v152, 16, v153
  v_and_b32 v153, s57, v153
  v_lshlrev_b32 v154, 16, v155
  v_and_b32 v155, s57, v155
  v_lshlrev_b32 v156, 16, v157
  v_and_b32 v157, s57, v157
  v_lshlrev_b32 v158, 16, v159
  v_and_b32 v159, s57, v159
  v_lshlrev_b32 v160, 16, v161
  v_and_b32 v161, s57, v161
  v_lshlrev_b32 v162, 16, v163
  v_and_b32 v163, s57, v163
  v_lshlrev_b32 v164, 16, v165
  v_and_b32 v165, s57, v165
  v_lshlrev_b32 v166, 16, v167
  v_and_b32 v167, s57, v167
  v_max3_f32 v192, v152, v153, v154
  v_max3_f32 v194, v156, v157, v158
  v_max3_f32 v196, v160, v161, v162
  v_max3_f32 v198, v164, v165, v166
  v_max_f32 v192, v192, v155
  v_max_f32 v194, v194, v159
  v_max_f32 v196, v196, v163
  v_max_f32 v198, v198, v167
  s_nop 1
  v_max_f32_dpp v192, v192, v192 row_ror:8 row_mask:0xf bank_mask:0xf
  v_max_f32_dpp v194, v194, v194 row_ror:8 row_mask:0xf bank_mask:0xf
  v_max_f32_dpp v196, v196, v196 row_ror:8 row_mask:0xf bank_mask:0xf
  v_max_f32_dpp v198, v198, v198 row_ror:8 row_mask:0xf bank_mask:0xf
  v_max_f32_dpp v192, v192, v192 row_ror:4 row_mask:0xf bank_mask:0xf
  v_max_f32_dpp v194, v194, v194 row_ror:4 row_mask:0xf bank_mask:0xf
  v_max_f32_dpp v196, v196, v196 row_ror:4 row_mask:0xf bank_mask:0xf
  v_max_f32_dpp v198, v198, v198 row_ror:4 row_mask:0xf bank_mask:0xf
  v_max_f32_dpp v192, v192, v192 row_ror:2 row_mask:0xf bank_mask:0xf
  v_max_f32_dpp v194, v194, v194 row_ror:2 row_mask:0xf bank_mask:0xf
  v_max_f32_dpp v196, v196, v196 row_ror:2 row_mask:0xf bank_mask:0xf
  v_max_f32_dpp v198, v198, v198 row_ror:2 row_mask:0xf bank_mask:0xf
  v_max_f32_dpp v192, v192, v192 row_ror:1 row_mask:0xf bank_mask:0xf
  v_max_f32_dpp v194, v194, v194 row_ror:1 row_mask:0xf bank_mask:0xf
  v_max_f32_dpp v196, v196, v196 row_ror:1 row_mask:0xf bank_mask:0xf
  v_max_f32_dpp v198, v198, v198 row_ror:1 row_mask:0xf bank_mask:0xf
  v_mov_b32 v200, v192
  v_mov_b32 v201, v194
  v_mov_b32 v202, v196
  v_mov_b32 v203, v198
  s_nop 1
  v_permlane32_swap_b32 v192, v200
  v_permlane32_swap_b32 v194, v201
  v_permlane32_swap_b32 v196, v202
  v_permlane32_swap_b32 v198, v203
  v_max_f32 v192, v192, v200
  v_max_f32 v194, v194, v201
  v_max_f32 v196, v196, v202
  v_max_f32 v198, v198, v203
  v_mov_b32 v200, v192
  v_mov_b32 v201, v194
  v_mov_b32 v202, v196
  v_mov_b32 v203, v198
  s_nop 1
  v_permlane16_swap_b32 v192, v200
  v_permlane16_swap_b32 v194, v201
  v_permlane16_swap_b32 v196, v202
  v_permlane16_swap_b32 v198, v203
  v_max_f32 v192, v192, v200
  v_max_f32 v194, v194, v201
  v_max_f32 v196, v196, v202
  v_max_f32 v198, v198, v203
  s_waitcnt vmcnt(4)
  buffer_load_dwordx4 v3, s[44:47], s54 offen offset:1024 nt lds
  s_mov_b32 s56, 0x3fb8aa3b
  v_mul_f32 v192, s56, v192
  v_mul_f32 v194, s56, v194
  v_mul_f32 v196, s56, v196
  v_mul_f32 v198, s56, v198
  v_fma_f32 v152, v152, s56, -v192
  v_fma_f32 v153, v153, s56, -v192
  v_fma_f32 v154, v154, s56, -v192
  v_fma_f32 v155, v155, s56, -v192
  v_fma_f32 v156, v156, s56, -v194
  v_fma_f32 v157, v157, s56, -v194
  v_fma_f32 v158, v158, s56, -v194
  v_fma_f32 v159, v159, s56, -v194
  v_fma_f32 v160, v160, s56, -v196
  v_fma_f32 v161, v161, s56, -v196
  v_fma_f32 v162, v162, s56, -v196
  v_fma_f32 v163, v163, s56, -v196
  v_fma_f32 v164, v164, s56, -v198
  v_fma_f32 v165, v165, s56, -v198
  v_fma_f32 v166, v166, s56, -v198
  v_fma_f32 v167, v167, s56, -v198
  v_exp_f32 v152, v152
  v_exp_f32 v153, v153
  v_exp_f32 v154, v154
  v_exp_f32 v155, v155
  v_exp_f32 v156, v156
  v_exp_f32 v157, v157
  v_exp_f32 v158, v158
  v_exp_f32 v159, v159
  v_exp_f32 v160, v160
  v_exp_f32 v161, v161
  v_exp_f32 v162, v162
  v_exp_f32 v163, v163
  v_exp_f32 v164, v164
  v_exp_f32 v165, v165
  v_exp_f32 v166, v166
  v_exp_f32 v167, v167
  s_waitcnt vmcnt(4)
  buffer_load_dwordx4 v4, s[44:47], s54 offen offset:2048 nt lds
  v_cvt_pk_bf16_f32 v168, v152, v153
  v_cvt_pk_bf16_f32 v169, v154, v155
  v_cvt_pk_bf16_f32 v170, v156, v157
  v_cvt_pk_bf16_f32 v171, v158, v159
  v_cvt_pk_bf16_f32 v172, v160, v161
  v_cvt_pk_bf16_f32 v173, v162, v163
  v_cvt_pk_bf16_f32 v174, v164, v165
  v_cvt_pk_bf16_f32 v175, v166, v167
  v_add_f32 v193, v152, v153
  v_add_f32 v154, v154, v155
  v_add_f32 v195, v156, v157
  v_add_f32 v158, v158, v159
  v_add_f32 v197, v160, v161
  v_add_f32 v162, v162, v163
  v_add_f32 v199, v164, v165
  v_add_f32 v166, v166, v167
  v_add_f32 v193, v193, v154
  v_add_f32 v195, v195, v158
  v_add_f32 v197, v197, v162
  v_add_f32 v199, v199, v166
  v_mov_b32_dpp v168, v168 row_ror:4 row_mask:0xf bank_mask:0xf
  v_mov_b32_dpp v169, v169 row_ror:4 row_mask:0xf bank_mask:0xf
  v_mov_b32_dpp v170, v170 row_ror:8 row_mask:0xf bank_mask:0xf
  v_mov_b32_dpp v171, v171 row_ror:8 row_mask:0xf bank_mask:0xf
  v_mov_b32_dpp v172, v172 row_ror:12 row_mask:0xf bank_mask:0xf
  v_mov_b32_dpp v173, v173 row_ror:12 row_mask:0xf bank_mask:0xf
  s_mov_b32 s50, 0x00080008
  s_mov_b32 s51, 0x00080008
  v_cndmask_b32 v190, 0, v168, s[50:51]
  v_cndmask_b32 v191, 0, v169, s[50:51]
  s_waitcnt vmcnt(4)
  buffer_load_dwordx4 v5, s[44:47], s54 offen offset:3072 nt lds
  s_add_u32 m0, s62, 4096
  v_mov_b32 v96, 0
  v_mov_b32 v97, 0
  v_mov_b32 v98, 0
  v_mov_b32 v99, 0
  v_mov_b32 v100, 0
  v_mov_b32 v101, 0
  v_mov_b32 v102, 0
  v_mov_b32 v103, 0
  v_mov_b32 v104, 0
  v_mov_b32 v105, 0
  v_mov_b32 v106, 0
  v_mov_b32 v107, 0
  v_mov_b32 v108, 0
  v_mov_b32 v109, 0
  v_mov_b32 v110, 0
  v_mov_b32 v111, 0
  v_mov_b32 v112, 0
  v_mov_b32 v113, 0
  v_mov_b32 v114, 0
  v_mov_b32 v115, 0
  v_mov_b32 v116, 0
  v_mov_b32 v117, 0
  v_mov_b32 v118, 0
  v_mov_b32 v119, 0
  v_mov_b32 v120, 0
  v_mov_b32 v121, 0
  v_mov_b32 v122, 0
  v_mov_b32 v123, 0
  v_mov_b32 v124, 0
  v_mov_b32 v125, 0
  v_mov_b32 v126, 0
  v_mov_b32 v127, 0
  v_mov_b32 v128, 0
  v_mov_b32 v129, 0
  v_mov_b32 v130, 0
  v_mov_b32 v131, 0
  v_mov_b32 v132, 0
  v_mov_b32 v133, 0
  v_mov_b32 v134, 0
  v_mov_b32 v135, 0
  v_mov_b32 v136, 0
  v_mov_b32 v137, 0
  v_mov_b32 v138, 0
  v_mov_b32 v139, 0
  v_mov_b32 v140, 0
  v_mov_b32 v141, 0
  v_mov_b32 v142, 0
  v_mov_b32 v143, 0
  s_waitcnt vmcnt(4)
  buffer_load_dwordx4 v6, s[44:47], s59 offen offset:0 nt lds
  s_nop 1
  v_add_f32_dpp v193, v193, v193 row_ror:8 row_mask:0xf bank_mask:0xf
  v_add_f32_dpp v195, v195, v195 row_ror:8 row_mask:0xf bank_mask:0xf
  v_add_f32_dpp v197, v197, v197 row_ror:8 row_mask:0xf bank_mask:0xf
  v_add_f32_dpp v199, v199, v199 row_ror:8 row_mask:0xf bank_mask:0xf
  v_add_f32_dpp v193, v193, v193 row_ror:4 row_mask:0xf bank_mask:0xf
  v_add_f32_dpp v195, v195, v195 row_ror:4 row_mask:0xf bank_mask:0xf
  v_add_f32_dpp v197, v197, v197 row_ror:4 row_mask:0xf bank_mask:0xf
  v_add_f32_dpp v199, v199, v199 row_ror:4 row_mask:0xf bank_mask:0xf
  v_add_f32_dpp v193, v193, v193 row_ror:2 row_mask:0xf bank_mask:0xf
  v_add_f32_dpp v195, v195, v195 row_ror:2 row_mask:0xf bank_mask:0xf
  v_add_f32_dpp v197, v197, v197 row_ror:2 row_mask:0xf bank_mask:0xf
  v_add_f32_dpp v199, v199, v199 row_ror:2 row_mask:0xf bank_mask:0xf
  v_add_f32_dpp v193, v193, v193 row_ror:1 row_mask:0xf bank_mask:0xf
  v_add_f32_dpp v195, v195, v195 row_ror:1 row_mask:0xf bank_mask:0xf
  v_add_f32_dpp v197, v197, v197 row_ror:1 row_mask:0xf bank_mask:0xf
  v_add_f32_dpp v199, v199, v199 row_ror:1 row_mask:0xf bank_mask:0xf
  v_mov_b32 v200, v193
  v_mov_b32 v201, v195
  v_mov_b32 v202, v197
  v_mov_b32 v203, v199
  s_nop 1
  v_permlane32_swap_b32 v193, v200
  v_permlane32_swap_b32 v195, v201
  v_permlane32_swap_b32 v197, v202
  v_permlane32_swap_b32 v199, v203
  v_add_f32 v193, v193, v200
  v_add_f32 v195, v195, v201
  v_add_f32 v197, v197, v202
  v_add_f32 v199, v199, v203
  v_mov_b32 v200, v193
  v_mov_b32 v201, v195
  v_mov_b32 v202, v197
  v_mov_b32 v203, v199
  s_nop 1
  v_permlane16_swap_b32 v193, v200
  v_permlane16_swap_b32 v195, v201
  v_permlane16_swap_b32 v197, v202
  v_permlane16_swap_b32 v199, v203
  v_add_f32 v193, v193, v200
  v_add_f32 v195, v195, v201
  v_add_f32 v197, v197, v202
  v_add_f32 v199, v199, v203
  s_lshl_b32 s57, s43, 5
  s_add_u32 s57, s57, 149056
  v_mov_b32 v176, s57
  v_bfe_u32 v177, v0, 2, 2
  v_mul_u32_u24 v177, 768, v177
  v_lshrrev_b32 v178, 4, v0
  v_lshl_add_u32 v178, v178, 4, v177
  s_mul_i32 s57, s43, 3072
  s_add_u32 s57, s57, 149504
  v_add_u32 v178, s57, v178
  v_mov_b32 v179, 148992
  v_mov_b32 v180, 1
  s_mov_b64 exec, 1
  ds_write_b128 v176, v[192:195]
  ds_write_b128 v176, v[196:199] offset:16
  ds_add_u32 v179, v180 offset:16
  s_mov_b64 exec, -1
  s_waitcnt vmcnt(4)
  buffer_load_dwordx4 v7, s[44:47], s59 offen offset:1024 nt lds
  s_add_u32 s89, s89, 196608
  s_cmp_ge_u32 s89, 3145728
  s_cselect_b32 s57, 3145728, 0
  s_sub_u32 s89, s89, s57
  s_add_u32 s88, s88, 1
  s_and_b32 s57, s88, 15
  s_cselect_b32 s57, 0, 100663296
  s_add_u32 s73, s73, s57
  s_add_u32 s54, s73, s89
  s_add_u32 s59, s54, 4096
  v_mfma_f32_16x16x16_bf16 v[96:99], v[48:49], v[190:191], v[96:99]
  v_mfma_f32_16x16x16_bf16 v[100:103], v[50:51], v[190:191], v[100:103]
  v_mfma_f32_16x16x16_bf16 v[104:107], v[52:53], v[190:191], v[104:107]
  v_mfma_f32_16x16x16_bf16 v[108:111], v[54:55], v[190:191], v[108:111]
  v_mfma_f32_16x16x16_bf16 v[112:115], v[56:57], v[190:191], v[112:115]
  v_mfma_f32_16x16x16_bf16 v[116:119], v[58:59], v[190:191], v[116:119]
  v_mfma_f32_16x16x16_bf16 v[120:123], v[60:61], v[190:191], v[120:123]
  v_mfma_f32_16x16x16_bf16 v[124:127], v[62:63], v[190:191], v[124:127]
  v_mfma_f32_16x16x16_bf16 v[128:131], v[64:65], v[190:191], v[128:131]
  v_mfma_f32_16x16x16_bf16 v[132:135], v[66:67], v[190:191], v[132:135]
  v_mfma_f32_16x16x16_bf16 v[136:139], v[68:69], v[190:191], v[136:139]
  v_mfma_f32_16x16x16_bf16 v[140:143], v[70:71], v[190:191], v[140:143]
  s_add_u32 s53, s53, 6144
  s_cmp_ge_u32 s53, 36864
  s_cselect_b32 s53, 0, s53
  v_add_u32 v17, s53, v13
  v_add_u32 v18, s53, v14
  v_add_u32 v19, s53, v15
  v_add_u32 v20, s53, v16
  ds_read_b64_tr_b16 v[72:73], v17 offset:0
  ds_read_b64_tr_b16 v[74:75], v18 offset:0
  ds_read_b64_tr_b16 v[76:77], v19 offset:0
  ds_read_b64_tr_b16 v[78:79], v20 offset:0
  ds_read_b64_tr_b16 v[80:81], v17 offset:128
  ds_read_b64_tr_b16 v[82:83], v18 offset:128
  ds_read_b64_tr_b16 v[84:85], v19 offset:128
  ds_read_b64_tr_b16 v[86:87], v20 offset:128
  ds_read_b64_tr_b16 v[88:89], v17 offset:256
  ds_read_b64_tr_b16 v[90:91], v18 offset:256
  ds_read_b64_tr_b16 v[92:93], v19 offset:256
  ds_read_b64_tr_b16 v[94:95], v20 offset:256
  v_mov_b32_dpp v168, v168 row_ror:1 row_mask:0xf bank_mask:0xf
  v_mov_b32_dpp v169, v169 row_ror:1 row_mask:0xf bank_mask:0xf
  v_cndmask_b32 v190, 0, v168, s[50:51]
  v_cndmask_b32 v191, 0, v169, s[50:51]
  s_mov_b32 s55, 29
  s_waitcnt lgkmcnt(0)
  s_branch L_oddV10
L_dispV:
  s_and_b32 s57, s58, 7
  s_cbranch_scc1 L_ngV
  v_mov_b32 v168, v170
  v_mov_b32 v169, v171
  v_mov_b32 v170, v172
  v_mov_b32 v171, v173
  v_mov_b32 v172, v174
  v_mov_b32 v173, v175
  s_lshl_b64 s[50:51], s[50:51], 4
  v_cndmask_b32 v190, 0, v168, s[50:51]
  v_cndmask_b32 v191, 0, v169, s[50:51]
  s_cmp_lg_u32 s58, 56
  s_cbranch_scc1 L_ngV
  s_mov_b32 exec_lo, 0x08880888
  s_mov_b32 exec_hi, 0x08880888
  ds_write_b128 v178, v[96:99] offset:0
  ds_write_b128 v178, v[100:103] offset:64
  ds_write_b128 v178, v[104:107] offset:128
  ds_write_b128 v178, v[108:111] offset:192
  ds_write_b128 v178, v[112:115] offset:256
  ds_write_b128 v178, v[116:119] offset:320
  ds_write_b128 v178, v[120:123] offset:384
  ds_write_b128 v178, v[124:127] offset:448
  ds_write_b128 v178, v[128:131] offset:512
  ds_write_b128 v178, v[132:135] offset:576
  ds_write_b128 v178, v[136:139] offset:640
  ds_write_b128 v178, v[140:143] offset:704
  s_mov_b64 exec, 1
  ds_add_u32 v179, v180 offset:28
  s_mov_b64 exec, -1
L_ngV:
  s_lshl_b32 s77, s76, 6
  s_mul_i32 s56, s79, s81
  s_sub_u32 s57, s77, s85
  s_mov_b32 s85, s77
  s_sub_u32 s57, s57, s56
  s_cmp_gt_i32 s57, 7680
  s_cselect_b32 s57, s57, 0
  s_add_u32 s86, s86, s57
  s_add_u32 s78, s78, s57
  s_add_u32 s78, s78, s56
  s_add_u32 s80, s80, s81
  s_sub_u32 s70, s77, s78
  s_bfe_u32 s57, s88, 0x50001
  s_sub_u32 s57, s57, s74
  s_cmp_lt_u32 s57, 12
  s_cselect_b32 s81, 5, 6
  s_cmp_eq_u32 s55, 0
  s_cbranch_scc1 L_outV
L_loopV:
  s_cmp_ge_u32 s80, s69
  s_cbranch_scc1 L_evV
L_retV:
  s_cmp_eq_u32 s81, 5
  s_cbranch_scc1 L_fastV
  s_cmp_gt_i32 s70, 7040
  s_cbranch_scc1 L_bV12
  s_cmp_gt_i32 s70, 1280
  s_cbranch_scc1 L_bV11
  s_cmp_gt_i32 s70, -960
  s_cbranch_scc1 L_bV10
  s_cmp_gt_i32 s70, -2880
  s_cbranch_scc1 L_bV9
  s_branch L_bV8
L_fastV:
  s_cmp_gt_i32 s70, 7040
  s_cbranch_scc1 L_bV16
  s_cmp_gt_i32 s70, 2880
  s_cbranch_scc1 L_bV14
  s_cmp_gt_i32 s70, 960
  s_cbranch_scc1 L_bV13
  s_cmp_gt_i32 s70, -960
  s_cbranch_scc1 L_bV12
  s_cmp_gt_i32 s70, -2880
  s_cbranch_scc1 L_bV11
  s_branch L_bV10
L_evV:
  s_cmp_eq_u32 s71, 1
  s_cbranch_scc1 L_ev1V
  s_cmp_eq_u32 s71, 2
  s_cbranch_scc1 L_ev2V
  s_sub_u32 s57, s80, s69
  s_mul_i32 s57, s57, s79
  s_sub_u32 s72, s77, s57
  s_mov_b32 s84, s69
  s_mov_b32 s87, s86
  s_mov_b32 s86, 0
  s_mov_b32 s71, 1
  s_add_u32 s69, s69, 11
  s_cmp_eq_u32 s68, 0
  s_cbranch_scc1 L_retV
  v_mov_b32 v184, s72
  s_mov_b64 exec, 1
  buffer_store_dwordx2 v[184:185], v182, s[64:67], s75 offen sc1
  s_mov_b64 exec, -1
  s_branch L_retV
L_ev1V:
  buffer_load_dwordx2 v[186:187], v183, s[64:67], s75 offen sc1
  s_mov_b32 s71, 2
  s_add_u32 s69, s80, 1
  s_add_u32 s75, s75, 512
  s_branch L_retV
L_ev2V:
  v_sub_u32 v186, s72, v186
  v_cmp_eq_u32 vcc, v185, v187
  v_cvt_f32_i32 v186, v186
  s_bcnt1_i32_b64 s57, vcc
  v_cndmask_b32 v186, 0, v186, vcc
  v_cvt_f32_u32 v188, s57
  s_nop 1
  s_nop 1
  v_add_f32_dpp v186, v186, v186 row_ror:8 row_mask:0xf bank_mask:0xf
  s_nop 1
  v_add_f32_dpp v186, v186, v186 row_ror:4 row_mask:0xf bank_mask:0xf
  s_nop 1
  v_add_f32_dpp v186, v186, v186 row_ror:2 row_mask:0xf bank_mask:0xf
  s_nop 1
  v_add_f32_dpp v186, v186, v186 row_ror:1 row_mask:0xf bank_mask:0xf
  v_mov_b32 v187, v186
  s_nop 1
  v_permlane32_swap_b32 v186, v187
  v_add_f32 v186, v186, v187
  v_mov_b32 v187, v186
  s_nop 1
  v_permlane16_swap_b32 v186, v187
  v_add_f32 v186, v186, v187
  v_max_f32 v188, 1.0, v188
  v_rcp_f32 v188, v188
  s_mov_b32 s71, 0
  s_add_u32 s69, s84, 60
  v_mul_f32 v186, v186, v188
  v_cvt_i32_f32 v187, v186
  s_nop 0
  v_readfirstlane_b32 s57, v187
  s_sub_u32 s57, s72, s57
  s_sub_u32 s82, s57, s83
  s_sub_u32 s82, s82, s87
  s_mov_b32 s83, s57
  s_mul_i32 s82, s82, 273
  s_lshr_b32 s82, s82, 14
  s_sub_u32 s82, s82, 7
  s_cmp_eq_u32 s84, 60
  s_cselect_b32 s79, s79, s82
  s_sub_u32 s78, s80, s84
  s_mul_i32 s78, s78, s79
  s_add_u32 s78, s78, s57
  s_add_u32 s78, s78, s86
  s_sub_u32 s70, s77, s78
  s_branch L_retV
L_bV8:
  s_add_u32 s62, s52, s53
  s_mov_b32 m0, s62
  s_waitcnt vmcnt(3)
  buffer_load_dwordx4 v2, s[44:47], s54 offen offset:0 nt lds
  v_mfma_f32_16x16x16_bf16 v[96:99], v[48:49], v[190:191], v[96:99]
  v_mfma_f32_16x16x16_bf16 v[100:103], v[50:51], v[190:191], v[100:103]
  v_mfma_f32_16x16x16_bf16 v[104:107], v[52:53], v[190:191], v[104:107]
  v_mfma_f32_16x16x16_bf16 v[108:111], v[54:55], v[190:191], v[108:111]
  v_mfma_f32_16x16x16_bf16 v[112:115], v[56:57], v[190:191], v[112:115]
  v_mfma_f32_16x16x16_bf16 v[116:119], v[58:59], v[190:191], v[116:119]
  v_mfma_f32_16x16x16_bf16 v[120:123], v[60:61], v[190:191], v[120:123]
  v_mfma_f32_16x16x16_bf16 v[124:127], v[62:63], v[190:191], v[124:127]
  v_mfma_f32_16x16x16_bf16 v[128:131], v[64:65], v[190:191], v[128:131]
  v_mfma_f32_16x16x16_bf16 v[132:135], v[66:67], v[190:191], v[132:135]
  v_mfma_f32_16x16x16_bf16 v[136:139], v[68:69], v[190:191], v[136:139]
  v_mfma_f32_16x16x16_bf16 v[140:143], v[70:71], v[190:191], v[140:143]
  s_waitcnt vmcnt(3)
  buffer_load_dwordx4 v3, s[44:47], s54 offen offset:1024 nt lds
  s_add_u32 s53, s53, 6144
  s_cmp_ge_u32 s53, 36864
  s_cselect_b32 s53, 0, s53
  v_add_u32 v17, s53, v13
  v_add_u32 v18, s53, v14
  v_add_u32 v19, s53, v15
  v_add_u32 v20, s53, v16
  ds_read_b64_tr_b16 v[72:73], v17 offset:0
  ds_read_b64_tr_b16 v[74:75], v18 offset:0
  ds_read_b64_tr_b16 v[76:77], v19 offset:0
  ds_read_b64_tr_b16 v[78:79], v20 offset:0
  ds_read_b64_tr_b16 v[80:81], v17 offset:128
  ds_read_b64_tr_b16 v[82:83], v18 offset:128
  ds_read_b64_tr_b16 v[84:85], v19 offset:128
  ds_read_b64_tr_b16 v[86:87], v20 offset:128
  ds_read_b64_tr_b16 v[88:89], v17 offset:256
  ds_read_b64_tr_b16 v[90:91], v18 offset:256
  ds_read_b64_tr_b16 v[92:93], v19 offset:256
  ds_read_b64_tr_b16 v[94:95], v20 offset:256
  s_waitcnt vmcnt(3)
  buffer_load_dwordx4 v4, s[44:47], s54 offen offset:2048 nt lds
  v_mov_b32_dpp v168, v168 row_ror:1 row_mask:0xf bank_mask:0xf
  v_mov_b32_dpp v169, v169 row_ror:1 row_mask:0xf bank_mask:0xf
  v_cndmask_b32 v190, 0, v168, s[50:51]
  v_cndmask_b32 v191, 0, v169, s[50:51]
  s_waitcnt vmcnt(3)
  buffer_load_dwordx4 v5, s[44:47], s54 offen offset:3072 nt lds
  s_add_u32 m0, s62, 4096
  s_waitcnt vmcnt(3)
  buffer_load_dwordx4 v6, s[44:47], s59 offen offset:0 nt lds
  s_waitcnt vmcnt(3)
  buffer_load_dwordx4 v7, s[44:47], s59 offen offset:1024 nt lds
  s_add_u32 s89, s89, 196608
  s_cmp_ge_u32 s89, 3145728
  s_cselect_b32 s57, 3145728, 0
  s_sub_u32 s89, s89, s57
  s_add_u32 s88, s88, 1
  s_and_b32 s57, s88, 15
  s_cselect_b32 s57, 0, 100663296
  s_add_u32 s73, s73, s57
  s_add_u32 s54, s73, s89
  s_add_u32 s59, s54, 4096
  s_waitcnt lgkmcnt(0)
L_oddV8:
  s_add_u32 s62, s52, s53
  s_mov_b32 m0, s62
  s_waitcnt vmcnt(3)
  buffer_load_dwordx4 v2, s[44:47], s54 offen offset:0 nt lds
  v_mfma_f32_16x16x16_bf16 v[96:99], v[72:73], v[190:191], v[96:99]
  v_mfma_f32_16x16x16_bf16 v[100:103], v[74:75], v[190:191], v[100:103]
  v_mfma_f32_16x16x16_bf16 v[104:107], v[76:77], v[190:191], v[104:107]
  v_mfma_f32_16x16x16_bf16 v[108:111], v[78:79], v[190:191], v[108:111]
  v_mfma_f32_16x16x16_bf16 v[112:115], v[80:81], v[190:191], v[112:115]
  v_mfma_f32_16x16x16_bf16 v[116:119], v[82:83], v[190:191], v[116:119]
  v_mfma_f32_16x16x16_bf16 v[120:123], v[84:85], v[190:191], v[120:123]
  v_mfma_f32_16x16x16_bf16 v[124:127], v[86:87], v[190:191], v[124:127]
  v_mfma_f32_16x16x16_bf16 v[128:131], v[88:89], v[190:191], v[128:131]
  v_mfma_f32_16x16x16_bf16 v[132:135], v[90:91], v[190:191], v[132:135]
  v_mfma_f32_16x16x16_bf16 v[136:139], v[92:93], v[190:191], v[136:139]
  v_mfma_f32_16x16x16_bf16 v[140:143], v[94:95], v[190:191], v[140:143]
  s_waitcnt vmcnt(3)
  buffer_load_dwordx4 v3, s[44:47], s54 offen offset:1024 nt lds
  s_add_u32 s53, s53, 6144
  s_cmp_ge_u32 s53, 36864
  s_cselect_b32 s53, 0, s53
  v_add_u32 v17, s53, v13
  v_add_u32 v18, s53, v14
  v_add_u32 v19, s53, v15
  v_add_u32 v20, s53, v16
  ds_read_b64_tr_b16 v[48:49], v17 offset:0
  ds_read_b64_tr_b16 v[50:51], v18 offset:0
  ds_read_b64_tr_b16 v[52:53], v19 offset:0
  ds_read_b64_tr_b16 v[54:55], v20 offset:0
  ds_read_b64_tr_b16 v[56:57], v17 offset:128
  ds_read_b64_tr_b16 v[58:59], v18 offset:128
  ds_read_b64_tr_b16 v[60:61], v19 offset:128
  ds_read_b64_tr_b16 v[62:63], v20 offset:128
  ds_read_b64_tr_b16 v[64:65], v17 offset:256
  ds_read_b64_tr_b16 v[66:67], v18 offset:256
  ds_read_b64_tr_b16 v[68:69], v19 offset:256
  ds_read_b64_tr_b16 v[70:71], v20 offset:256
  s_waitcnt vmcnt(3)
  buffer_load_dwordx4 v4, s[44:47], s54 offen offset:2048 nt lds
  v_mov_b32_dpp v168, v168 row_ror:1 row_mask:0xf bank_mask:0xf
  v_mov_b32_dpp v169, v169 row_ror:1 row_mask:0xf bank_mask:0xf
  v_cndmask_b32 v190, 0, v168, s[50:51]
  v_cndmask_b32 v191, 0, v169, s[50:51]
  s_waitcnt vmcnt(3)
  buffer_load_dwordx4 v5, s[44:47], s54 offen offset:3072 nt lds
  s_add_u32 m0, s62, 4096
  s_waitcnt vmcnt(3)
  buffer_load_dwordx4 v6, s[44:47], s59 offen offset:0 nt lds
  s_waitcnt vmcnt(3)
  buffer_load_dwordx4 v7, s[44:47], s59 offen offset:1024 nt lds
  s_add_u32 s89, s89, 196608
  s_cmp_ge_u32 s89, 3145728
  s_cselect_b32 s57, 3145728, 0
  s_sub_u32 s89, s89, s57
  s_add_u32 s88, s88, 1
  s_and_b32 s57, s88, 15
  s_cselect_b32 s57, 0, 100663296
  s_add_u32 s73, s73, s57
  s_add_u32 s54, s73, s89
  s_add_u32 s59, s54, 4096
  s_memrealtime s[76:77]
  s_waitcnt lgkmcnt(0)
  s_add_u32 s58, s58, 1
  s_sub_u32 s55, s55, 1
  s_branch L_dispV
L_bV9:
  s_add_u32 s62, s52, s53
  s_mov_b32 m0, s62
  s_waitcnt vmcnt(3)
  buffer_load_dwordx4 v2, s[44:47], s54 offen offset:0 nt lds
  v_mfma_f32_16x16x16_bf16 v[96:99], v[48:49], v[190:191], v[96:99]
  v_mfma_f32_16x16x16_bf16 v[100:103], v[50:51], v[190:191], v[100:103]
  v_mfma_f32_16x16x16_bf16 v[104:107], v[52:53], v[190:191], v[104:107]
  v_mfma_f32_16x16x16_bf16 v[108:111], v[54:55], v[190:191], v[108:111]
  v_mfma_f32_16x16x16_bf16 v[112:115], v[56:57], v[190:191], v[112:115]
  v_mfma_f32_16x16x16_bf16 v[116:119], v[58:59], v[190:191], v[116:119]
  v_mfma_f32_16x16x16_bf16 v[120:123], v[60:61], v[190:191], v[120:123]
  v_mfma_f32_16x16x16_bf16 v[124:127], v[62:63], v[190:191], v[124:127]
  v_mfma_f32_16x16x16_bf16 v[128:131], v[64:65], v[190:191], v[128:131]
  v_mfma_f32_16x16x16_bf16 v[132:135], v[66:67], v[190:191], v[132:135]
  v_mfma_f32_16x16x16_bf16 v[136:139], v[68:69], v[190:191], v[136:139]
  v_mfma_f32_16x16x16_bf16 v[140:143], v[70:71], v[190:191], v[140:143]
  s_waitcnt vmcnt(4)
  buffer_load_dwordx4 v3, s[44:47], s54 offen offset:1024 nt lds
  s_add_u32 s53, s53, 6144
  s_cmp_ge_u32 s53, 36864
  s_cselect_b32 s53, 0, s53
  v_add_u32 v17, s53, v13
  v_add_u32 v18, s53, v14
  v_add_u32 v19, s53, v15
  v_add_u32 v20, s53, v16
  ds_read_b64_tr_b16 v[72:73], v17 offset:0
  ds_read_b64_tr_b16 v[74:75], v18 offset:0
  ds_read_b64_tr_b16 v[76:77], v19 offset:0
  ds_read_b64_tr_b16 v[78:79], v20 offset:0
  ds_read_b64_tr_b16 v[80:81], v17 offset:128
  ds_read_b64_tr_b16 v[82:83], v18 offset:128
  ds_read_b64_tr_b16 v[84:85], v19 offset:128
  ds_read_b64_tr_b16 v[86:87], v20 offset:128
  ds_read_b64_tr_b16 v[88:89], v17 offset:256
  ds_read_b64_tr_b16 v[90:91], v18 offset:256
  ds_read_b64_tr_b16 v[92:93], v19 offset:256
  ds_read_b64_tr_b16 v[94:95], v20 offset:256
  s_waitcnt vmcnt(3)
  buffer_load_dwordx4 v4, s[44:47], s54 offen offset:2048 nt lds
  v_mov_b32_dpp v168, v168 row_ror:1 row_mask:0xf bank_mask:0xf
  v_mov_b32_dpp v169, v169 row_ror:1 row_mask:0xf bank_mask:0xf
  v_cndmask_b32 v190, 0, v168, s[50:51]
  v_cndmask_b32 v191, 0, v169, s[50:51]
  s_waitcnt vmcnt(4)
  buffer_load_dwordx4 v5, s[44:47], s54 offen offset:3072 nt lds
  s_add_u32 m0, s62, 4096
  s_waitcnt vmcnt(3)
  buffer_load_dwordx4 v6, s[44:47], s59 offen offset:0 nt lds
  s_waitcnt vmcnt(4)
  buffer_load_dwordx4 v7, s[44:47], s59 offen offset:1024 nt lds
  s_add_u32 s89, s89, 196608
  s_cmp_ge_u32 s89, 3145728
  s_cselect_b32 s57, 3145728, 0
  s_sub_u32 s89, s89, s57
  s_add_u32 s88, s88, 1
  s_and_b32 s57, s88, 15
  s_cselect_b32 s57, 0, 100663296
  s_add_u32 s73, s73, s57
  s_add_u32 s54, s73, s89
  s_add_u32 s59, s54, 4096
  s_waitcnt lgkmcnt(0)
L_oddV9:
  s_add_u32 s62, s52, s53
  s_mov_b32 m0, s62
  s_waitcnt vmcnt(3)
  buffer_load_dwordx4 v2, s[44:47], s54 offen offset:0 nt lds
  v_mfma_f32_16x16x16_bf16 v[96:99], v[72:73], v[190:191], v[96:99]
  v_mfma_f32_16x16x16_bf16 v[100:103], v[74:75], v[190:191], v[100:103]
  v_mfma_f32_16x16x16_bf16 v[104:107], v[76:77], v[190:191], v[104:107]
  v_mfma_f32_16x16x16_bf16 v[108:111], v[78:79], v[190:191], v[108:111]
  v_mfma_f32_16x16x16_bf16 v[112:115], v[80:81], v[190:191], v[112:115]
  v_mfma_f32_16x16x16_bf16 v[116:119], v[82:83], v[190:191], v[116:119]
  v_mfma_f32_16x16x16_bf16 v[120:123], v[84:85], v[190:191], v[120:123]
  v_mfma_f32_16x16x16_bf16 v[124:127], v[86:87], v[190:191], v[124:127]
  v_mfma_f32_16x16x16_bf16 v[128:131], v[88:89], v[190:191], v[128:131]
  v_mfma_f32_16x16x16_bf16 v[132:135], v[90:91], v[190:191], v[132:135]
  v_mfma_f32_16x16x16_bf16 v[136:139], v[92:93], v[190:191], v[136:139]
  v_mfma_f32_16x16x16_bf16 v[140:143], v[94:95], v[190:191], v[140:143]
  s_waitcnt vmcnt(4)
  buffer_load_dwordx4 v3, s[44:47], s54 offen offset:1024 nt lds
  s_add_u32 s53, s53, 6144
  s_cmp_ge_u32 s53, 36864
  s_cselect_b32 s53, 0, s53
  v_add_u32 v17, s53, v13
  v_add_u32 v18, s53, v14
  v_add_u32 v19, s53, v15
  v_add_u32 v20, s53, v16
  ds_read_b64_tr_b16 v[48:49], v17 offset:0
  ds_read_b64_tr_b16 v[50:51], v18 offset:0
  ds_read_b64_tr_b16 v[52:53], v19 offset:0
  ds_read_b64_tr_b16 v[54:55], v20 offset:0
  ds_read_b64_tr_b16 v[56:57], v17 offset:128
  ds_read_b64_tr_b16 v[58:59], v18 offset:128
  ds_read_b64_tr_b16 v[60:61], v19 offset:128
  ds_read_b64_tr_b16 v[62:63], v20 offset:128
  ds_read_b64_tr_b16 v[64:65], v17 offset:256
  ds_read_b64_tr_b16 v[66:67], v18 offset:256
  ds_read_b64_tr_b16 v[68:69], v19 offset:256
  ds_read_b64_tr_b16 v[70:71], v20 offset:256
  s_waitcnt vmcnt(3)
  buffer_load_dwordx4 v4, s[44:47], s54 offen offset:2048 nt lds
  v_mov_b32_dpp v168, v168 row_ror:1 row_mask:0xf bank_mask:0xf
  v_mov_b32_dpp v169, v169 row_ror:1 row_mask:0xf bank_mask:0xf
  v_cndmask_b32 v190, 0, v168, s[50:51]
  v_cndmask_b32 v191, 0, v169, s[50:51]
  s_waitcnt vmcnt(4)
  buffer_load_dwordx4 v5, s[44:47], s54 offen offset:3072 nt lds
  s_add_u32 m0, s62, 4096
  s_waitcnt vmcnt(3)
  buffer_load_dwordx4 v6, s[44:47], s59 offen offset:0 nt lds
  s_waitcnt vmcnt(4)
  buffer_load_dwordx4 v7, s[44:47], s59 offen offset:1024 nt lds
  s_add_u32 s89, s89, 196608
  s_cmp_ge_u32 s89, 3145728
  s_cselect_b32 s57, 3145728, 0
  s_sub_u32 s89, s89, s57
  s_add_u32 s88, s88, 1
  s_and_b32 s57, s88, 15
  s_cselect_b32 s57, 0, 100663296
  s_add_u32 s73, s73, s57
  s_add_u32 s54, s73, s89
  s_add_u32 s59, s54, 4096
  s_memrealtime s[76:77]
  s_waitcnt lgkmcnt(0)
  s_add_u32 s58, s58, 1
  s_sub_u32 s55, s55, 1
  s_branch L_dispV
L_bV10:
  s_add_u32 s62, s52, s53
  s_mov_b32 m0, s62
  s_waitcnt vmcnt(4)
  buffer_load_dwordx4 v2, s[44:47], s54 offen offset:0 nt lds
  v_mfma_f32_16x16x16_bf16 v[96:99], v[48:49], v[190:191], v[96:99]
  v_mfma_f32_16x16x16_bf16 v[100:103], v[50:51], v[190:191], v[100:103]
  v_mfma_f32_16x16x16_bf16 v[104:107], v[52:53], v[190:191], v[104:107]
  v_mfma_f32_16x16x16_bf16 v[108:111], v[54:55], v[190:191], v[108:111]
  v_mfma_f32_16x16x16_bf16 v[112:115], v[56:57], v[190:191], v[112:115]
  v_mfma_f32_16x16x16_bf16 v[116:119], v[58:59], v[190:191], v[116:119]
  v_mfma_f32_16x16x16_bf16 v[120:123], v[60:61], v[190:191], v[120:123]
  v_mfma_f32_16x16x16_bf16 v[124:127], v[62:63], v[190:191], v[124:127]
  v_mfma_f32_16x16x16_bf16 v[128:131], v[64:65], v[190:191], v[128:131]
  v_mfma_f32_16x16x16_bf16 v[132:135], v[66:67], v[190:191], v[132:135]
  v_mfma_f32_16x16x16_bf16 v[136:139], v[68:69], v[190:191], v[136:139]
  v_mfma_f32_16x16x16_bf16 v[140:143], v[70:71], v[190:191], v[140:143]
  s_waitcnt vmcnt(4)
  buffer_load_dwordx4 v3, s[44:47], s54 offen offset:1024 nt lds
  s_add_u32 s53, s53, 6144
  s_cmp_ge_u32 s53, 36864
  s_cselect_b32 s53, 0, s53
  v_add_u32 v17, s53, v13
  v_add_u32 v18, s53, v14
  v_add_u32 v19, s53, v15
  v_add_u32 v20, s53, v16
  ds_read_b64_tr_b16 v[72:73], v17 offset:0
  ds_read_b64_tr_b16 v[74:75], v18 offset:0
  ds_read_b64_tr_b16 v[76:77], v19 offset:0
  ds_read_b64_tr_b16 v[78:79], v20 offset:0
  ds_read_b64_tr_b16 v[80:81], v17 offset:128
  ds_read_b64_tr_b16 v[82:83], v18 offset:128
  ds_read_b64_tr_b16 v[84:85], v19 offset:128
  ds_read_b64_tr_b16 v[86:87], v20 offset:128
  ds_read_b64_tr_b16 v[88:89], v17 offset:256
  ds_read_b64_tr_b16 v[90:91], v18 offset:256
  ds_read_b64_tr_b16 v[92:93], v19 offset:256
  ds_read_b64_tr_b16 v[94:95], v20 offset:256
  s_waitcnt vmcnt(4)
  buffer_load_dwordx4 v4, s[44:47], s54 offen offset:2048 nt lds
  v_mov_b32_dpp v168, v168 row_ror:1 row_mask:0xf bank_mask:0xf
  v_mov_b32_dpp v169, v169 row_ror:1 row_mask:0xf bank_mask:0xf
  v_cndmask_b32 v190, 0, v168, s[50:51]
  v_cndmask_b32 v191, 0, v169, s[50:51]
  s_waitcnt vmcnt(4)
  buffer_load_dwordx4 v5, s[44:47], s54 offen offset:3072 nt lds
  s_add_u32 m0, s62, 4096
  s_waitcnt vmcnt(4)
  buffer_load_dwordx4 v6, s[44:47], s59 offen offset:0 nt lds
  s_waitcnt vmcnt(4)
  buffer_load_dwordx4 v7, s[44:47], s59 offen offset:1024 nt lds
  s_add_u32 s89, s89, 196608
  s_cmp_ge_u32 s89, 3145728
  s_cselect_b32 s57, 3145728, 0
  s_sub_u32 s89, s89, s57
  s_add_u32 s88, s88, 1
  s_and_b32 s57, s88, 15
  s_cselect_b32 s57, 0, 100663296
  s_add_u32 s73, s73, s57
  s_add_u32 s54, s73, s89
  s_add_u32 s59, s54, 4096
  s_waitcnt lgkmcnt(0)
L_oddV10:
  s_add_u32 s62, s52, s53
  s_mov_b32 m0, s62
  s_waitcnt vmcnt(4)
  buffer_load_dwordx4 v2, s[44:47], s54 offen offset:0 nt lds
  v_mfma_f32_16x16x16_bf16 v[96:99], v[72:73], v[190:191], v[96:99]
  v_mfma_f32_16x16x16_bf16 v[100:103], v[74:75], v[190:191], v[100:103]
  v_mfma_f32_16x16x16_bf16 v[104:107], v[76:77], v[190:191], v[104:107]
  v_mfma_f32_16x16x16_bf16 v[108:111], v[78:79], v[190:191], v[108:111]
  v_mfma_f32_16x16x16_bf16 v[112:115], v[80:81], v[190:191], v[112:115]
  v_mfma_f32_16x16x16_bf16 v[116:119], v[82:83], v[190:191], v[116:119]
  v_mfma_f32_16x16x16_bf16 v[120:123], v[84:85], v[190:191], v[120:123]
  v_mfma_f32_16x16x16_bf16 v[124:127], v[86:87], v[190:191], v[124:127]
  v_mfma_f32_16x16x16_bf16 v[128:131], v[88:89], v[190:191], v[128:131]
  v_mfma_f32_16x16x16_bf16 v[132:135], v[90:91], v[190:191], v[132:135]
  v_mfma_f32_16x16x16_bf16 v[136:139], v[92:93], v[190:191], v[136:139]
  v_mfma_f32_16x16x16_bf16 v[140:143], v[94:95], v[190:191], v[140:143]
  s_waitcnt vmcnt(4)
  buffer_load_dwordx4 v3, s[44:47], s54 offen offset:1024 nt lds
  s_add_u32 s53, s53, 6144
  s_cmp_ge_u32 s53, 36864
  s_cselect_b32 s53, 0, s53
  v_add_u32 v17, s53, v13
  v_add_u32 v18, s53, v14
  v_add_u32 v19, s53, v15
  v_add_u32 v20, s53, v16
  ds_read_b64_tr_b16 v[48:49], v17 offset:0
  ds_read_b64_tr_b16 v[50:51], v18 offset:0
  ds_read_b64_tr_b16 v[52:53], v19 offset:0
  ds_read_b64_tr_b16 v[54:55], v20 offset:0
  ds_read_b64_tr_b16 v[56:57], v17 offset:128
  ds_read_b64_tr_b16 v[58:59], v18 offset:128
  ds_read_b64_tr_b16 v[60:61], v19 offset:128
  ds_read_b64_tr_b16 v[62:63], v20 offset:128
  ds_read_b64_tr_b16 v[64:65], v17 offset:256
  ds_read_b64_tr_b16 v[66:67], v18 offset:256
  ds_read_b64_tr_b16 v[68:69], v19 offset:256
  ds_read_b64_tr_b16 v[70:71], v20 offset:256
  s_waitcnt vmcnt(4)
  buffer_load_dwordx4 v4, s[44:47], s54 offen offset:2048 nt lds
  v_mov_b32_dpp v168, v168 row_ror:1 row_mask:0xf bank_mask:0xf
  v_mov_b32_dpp v169, v169 row_ror:1 row_mask:0xf bank_mask:0xf
  v_cndmask_b32 v190, 0, v168, s[50:51]
  v_cndmask_b32 v191, 0, v169, s[50:51]
  s_waitcnt vmcnt(4)
  buffer_load_dwordx4 v5, s[44:47], s54 offen offset:3072 nt lds
  s_add_u32 m0, s62, 4096
  s_waitcnt vmcnt(4)
  buffer_load_dwordx4 v6, s[44:47], s59 offen offset:0 nt lds
  s_waitcnt vmcnt(4)
  buffer_load_dwordx4 v7, s[44:47], s59 offen offset:1024 nt lds
  s_add_u32 s89, s89, 196608
  s_cmp_ge_u32 s89, 3145728
  s_cselect_b32 s57, 3145728, 0
  s_sub_u32 s89, s89, s57
  s_add_u32 s88, s88, 1
  s_and_b32 s57, s88, 15
  s_cselect_b32 s57, 0, 100663296
  s_add_u32 s73, s73, s57
  s_add_u32 s54, s73, s89
  s_add_u32 s59, s54, 4096
  s_memrealtime s[76:77]
  s_waitcnt lgkmcnt(0)
  s_add_u32 s58, s58, 1
  s_sub_u32 s55, s55, 1
  s_branch L_dispV
L_bV11:
  s_add_u32 s62, s52, s53
  s_mov_b32 m0, s62
  s_waitcnt vmcnt(4)
  buffer_load_dwordx4 v2, s[44:47], s54 offen offset:0 nt lds
  v_mfma_f32_16x16x16_bf16 v[96:99], v[48:49], v[190:191], v[96:99]
  v_mfma_f32_16x16x16_bf16 v[100:103], v[50:51], v[190:191], v[100:103]
  v_mfma_f32_16x16x16_bf16 v[104:107], v[52:53], v[190:191], v[104:107]
  v_mfma_f32_16x16x16_bf16 v[108:111], v[54:55], v[190:191], v[108:111]
  v_mfma_f32_16x16x16_bf16 v[112:115], v[56:57], v[190:191], v[112:115]
  v_mfma_f32_16x16x16_bf16 v[116:119], v[58:59], v[190:191], v[116:119]
  v_mfma_f32_16x16x16_bf16 v[120:123], v[60:61], v[190:191], v[120:123]
  v_mfma_f32_16x16x16_bf16 v[124:127], v[62:63], v[190:191], v[124:127]
  v_mfma_f32_16x16x16_bf16 v[128:131], v[64:65], v[190:191], v[128:131]
  v_mfma_f32_16x16x16_bf16 v[132:135], v[66:67], v[190:191], v[132:135]
  v_mfma_f32_16x16x16_bf16 v[136:139], v[68:69], v[190:191], v[136:139]
  v_mfma_f32_16x16x16_bf16 v[140:143], v[70:71], v[190:191], v[140:143]
  s_waitcnt vmcnt(5)
  buffer_load_dwordx4 v3, s[44:47], s54 offen offset:1024 nt lds
  s_add_u32 s53, s53, 6144
  s_cmp_ge_u32 s53, 36864
  s_cselect_b32 s53, 0, s53
  v_add_u32 v17, s53, v13
  v_add_u32 v18, s53, v14
  v_add_u32 v19, s53, v15
  v_add_u32 v20, s53, v16
  ds_read_b64_tr_b16 v[72:73], v17 offset:0
  ds_read_b64_tr_b16 v[74:75], v18 offset:0
  ds_read_b64_tr_b16 v[76:77], v19 offset:0
  ds_read_b64_tr_b16 v[78:79], v20 offset:0
  ds_read_b64_tr_b16 v[80:81], v17 offset:128
  ds_read_b64_tr_b16 v[82:83], v18 offset:128
  ds_read_b64_tr_b16 v[84:85], v19 offset:128
  ds_read_b64_tr_b16 v[86:87], v20 offset:128
  ds_read_b64_tr_b16 v[88:89], v17 offset:256
  ds_read_b64_tr_b16 v[90:91], v18 offset:256
  ds_read_b64_tr_b16 v[92:93], v19 offset:256
  ds_read_b64_tr_b16 v[94:95], v20 offset:256
  s_waitcnt vmcnt(4)
  buffer_load_dwordx4 v4, s[44:47], s54 offen offset:2048 nt lds
  v_mov_b32_dpp v168, v168 row_ror:1 row_mask:0xf bank_mask:0xf
  v_mov_b32_dpp v169, v169 row_ror:1 row_mask:0xf bank_mask:0xf
  v_cndmask_b32 v190, 0, v168, s[50:51]
  v_cndmask_b32 v191, 0, v169, s[50:51]
  s_waitcnt vmcnt(5)
  buffer_load_dwordx4 v5, s[44:47], s54 offen offset:3072 nt lds
  s_add_u32 m0, s62, 4096
  s_waitcnt vmcnt(4)
  buffer_load_dwordx4 v6, s[44:47], s59 offen offset:0 nt lds
  s_waitcnt vmcnt(5)
  buffer_load_dwordx4 v7, s[44:47], s59 offen offset:1024 nt lds
  s_add_u32 s89, s89, 196608
  s_cmp_ge_u32 s89, 3145728
  s_cselect_b32 s57, 3145728, 0
  s_sub_u32 s89, s89, s57
  s_add_u32 s88, s88, 1
  s_and_b32 s57, s88, 15
  s_cselect_b32 s57, 0, 100663296
  s_add_u32 s73, s73, s57
  s_add_u32 s54, s73, s89
  s_add_u32 s59, s54, 4096
  s_waitcnt lgkmcnt(0)
L_oddV11:
  s_add_u32 s62, s52, s53
  s_mov_b32 m0, s62
  s_waitcnt vmcnt(4)
  buffer_load_dwordx4 v2, s[44:47], s54 offen offset:0 nt lds
  v_mfma_f32_16x16x16_bf16 v[96:99], v[72:73], v[190:191], v[96:99]
  v_mfma_f32_16x16x16_bf16 v[100:103], v[74:75], v[190:191], v[100:103]
  v_mfma_f32_16x16x16_bf16 v[104:107], v[76:77], v[190:191], v[104:107]
  v_mfma_f32_16x16x16_bf16 v[108:111], v[78:79], v[190:191], v[108:111]
  v_mfma_f32_16x16x16_bf16 v[112:115], v[80:81], v[190:191], v[112:115]
  v_mfma_f32_16x16x16_bf16 v[116:119], v[82:83], v[190:191], v[116:119]
  v_mfma_f32_16x16x16_bf16 v[120:123], v[84:85], v[190:191], v[120:123]
  v_mfma_f32_16x16x16_bf16 v[124:127], v[86:87], v[190:191], v[124:127]
  v_mfma_f32_16x16x16_bf16 v[128:131], v[88:89], v[190:191], v[128:131]
  v_mfma_f32_16x16x16_bf16 v[132:135], v[90:91], v[190:191], v[132:135]
  v_mfma_f32_16x16x16_bf16 v[136:139], v[92:93], v[190:191], v[136:139]
  v_mfma_f32_16x16x16_bf16 v[140:143], v[94:95], v[190:191], v[140:143]
  s_waitcnt vmcnt(5)
  buffer_load_dwordx4 v3, s[44:47], s54 offen offset:1024 nt lds
  s_add_u32 s53, s53, 6144
  s_cmp_ge_u32 s53, 36864
  s_cselect_b32 s53, 0, s53
  v_add_u32 v17, s53, v13
  v_add_u32 v18, s53, v14
  v_add_u32 v19, s53, v15
  v_add_u32 v20, s53, v16
  ds_read_b64_tr_b16 v[48:49], v17 offset:0
  ds_read_b64_tr_b16 v[50:51], v18 offset:0
  ds_read_b64_tr_b16 v[52:53], v19 offset:0
  ds_read_b64_tr_b16 v[54:55], v20 offset:0
  ds_read_b64_tr_b16 v[56:57], v17 offset:128
  ds_read_b64_tr_b16 v[58:59], v18 offset:128
  ds_read_b64_tr_b16 v[60:61], v19 offset:128
  ds_read_b64_tr_b16 v[62:63], v20 offset:128
  ds_read_b64_tr_b16 v[64:65], v17 offset:256
  ds_read_b64_tr_b16 v[66:67], v18 offset:256
  ds_read_b64_tr_b16 v[68:69], v19 offset:256
  ds_read_b64_tr_b16 v[70:71], v20 offset:256
  s_waitcnt vmcnt(4)
  buffer_load_dwordx4 v4, s[44:47], s54 offen offset:2048 nt lds
  v_mov_b32_dpp v168, v168 row_ror:1 row_mask:0xf bank_mask:0xf
  v_mov_b32_dpp v169, v169 row_ror:1 row_mask:0xf bank_mask:0xf
  v_cndmask_b32 v190, 0, v168, s[50:51]
  v_cndmask_b32 v191, 0, v169, s[50:51]
  s_waitcnt vmcnt(5)
  buffer_load_dwordx4 v5, s[44:47], s54 offen offset:3072 nt lds
  s_add_u32 m0, s62, 4096
  s_waitcnt vmcnt(4)
  buffer_load_dwordx4 v6, s[44:47], s59 offen offset:0 nt lds
  s_waitcnt vmcnt(5)
  buffer_load_dwordx4 v7, s[44:47], s59 offen offset:1024 nt lds
  s_add_u32 s89, s89, 196608
  s_cmp_ge_u32 s89, 3145728
  s_cselect_b32 s57, 3145728, 0
  s_sub_u32 s89, s89, s57
  s_add_u32 s88, s88, 1
  s_and_b32 s57, s88, 15
  s_cselect_b32 s57, 0, 100663296
  s_add_u32 s73, s73, s57
  s_add_u32 s54, s73, s89
  s_add_u32 s59, s54, 4096
  s_memrealtime s[76:77]
  s_waitcnt lgkmcnt(0)
  s_add_u32 s58, s58, 1
  s_sub_u32 s55, s55, 1
  s_branch L_dispV
L_bV12:
  s_add_u32 s62, s52, s53
  s_mov_b32 m0, s62
  s_waitcnt vmcnt(5)
  buffer_load_dwordx4 v2, s[44:47], s54 offen offset:0 nt lds
  v_mfma_f32_16x16x16_bf16 v[96:99], v[48:49], v[190:191], v[96:99]
  v_mfma_f32_16x16x16_bf16 v[100:103], v[50:51], v[190:191], v[100:103]
  v_mfma_f32_16x16x16_bf16 v[104:107], v[52:53], v[190:191], v[104:107]
  v_mfma_f32_16x16x16_bf16 v[108:111], v[54:55], v[190:191], v[108:111]
  v_mfma_f32_16x16x16_bf16 v[112:115], v[56:57], v[190:191], v[112:115]
  v_mfma_f32_16x16x16_bf16 v[116:119], v[58:59], v[190:191], v[116:119]
  v_mfma_f32_16x16x16_bf16 v[120:123], v[60:61], v[190:191], v[120:123]
  v_mfma_f32_16x16x16_bf16 v[124:127], v[62:63], v[190:191], v[124:127]
  v_mfma_f32_16x16x16_bf16 v[128:131], v[64:65], v[190:191], v[128:131]
  v_mfma_f32_16x16x16_bf16 v[132:135], v[66:67], v[190:191], v[132:135]
  v_mfma_f32_16x16x16_bf16 v[136:139], v[68:69], v[190:191], v[136:139]
  v_mfma_f32_16x16x16_bf16 v[140:143], v[70:71], v[190:191], v[140:143]
  s_waitcnt vmcnt(5)
  buffer_load_dwordx4 v3, s[44:47], s54 offen offset:1024 nt lds
  s_add_u32 s53, s53, 6144
  s_cmp_ge_u32 s53, 36864
  s_cselect_b32 s53, 0, s53
  v_add_u32 v17, s53, v13
  v_add_u32 v18, s53, v14
  v_add_u32 v19, s53, v15
  v_add_u32 v20, s53, v16
  ds_read_b64_tr_b16 v[72:73], v17 offset:0
  ds_read_b64_tr_b16 v[74:75], v18 offset:0
  ds_read_b64_tr_b16 v[76:77], v19 offset:0
  ds_read_b64_tr_b16 v[78:79], v20 offset:0
  ds_read_b64_tr_b16 v[80:81], v17 offset:128
  ds_read_b64_tr_b16 v[82:83], v18 offset:128
  ds_read_b64_tr_b16 v[84:85], v19 offset:128
  ds_read_b64_tr_b16 v[86:87], v20 offset:128
  ds_read_b64_tr_b16 v[88:89], v17 offset:256
  ds_read_b64_tr_b16 v[90:91], v18 offset:256
  ds_read_b64_tr_b16 v[92:93], v19 offset:256
  ds_read_b64_tr_b16 v[94:95], v20 offset:256
  s_waitcnt vmcnt(5)
  buffer_load_dwordx4 v4, s[44:47], s54 offen offset:2048 nt lds
  v_mov_b32_dpp v168, v168 row_ror:1 row_mask:0xf bank_mask:0xf
  v_mov_b32_dpp v169, v169 row_ror:1 row_mask:0xf bank_mask:0xf
  v_cndmask_b32 v190, 0, v168, s[50:51]
  v_cndmask_b32 v191, 0, v169, s[50:51]
  s_waitcnt vmcnt(5)
  buffer_load_dwordx4 v5, s[44:47], s54 offen offset:3072 nt lds
  s_add_u32 m0, s62, 4096
  s_waitcnt vmcnt(5)
  buffer_load_dwordx4 v6, s[44:47], s59 offen offset:0 nt lds
  s_waitcnt vmcnt(5)
  buffer_load_dwordx4 v7, s[44:47], s59 offen offset:1024 nt lds
  s_add_u32 s89, s89, 196608
  s_cmp_ge_u32 s89, 3145728
  s_cselect_b32 s57, 3145728, 0
  s_sub_u32 s89, s89, s57
  s_add_u32 s88, s88, 1
  s_and_b32 s57, s88, 15
  s_cselect_b32 s57, 0, 100663296
  s_add_u32 s73, s73, s57
  s_add_u32 s54, s73, s89
  s_add_u32 s59, s54, 4096
  s_waitcnt lgkmcnt(0)
L_oddV12:
  s_add_u32 s62, s52, s53
  s_mov_b32 m0, s62
  s_waitcnt vmcnt(5)
  buffer_load_dwordx4 v2, s[44:47], s54 offen offset:0 nt lds
  v_mfma_f32_16x16x16_bf16 v[96:99], v[72:73], v[190:191], v[96:99]
  v_mfma_f32_16x16x16_bf16 v[100:103], v[74:75], v[190:191], v[100:103]
  v_mfma_f32_16x16x16_bf16 v[104:107], v[76:77], v[190:191], v[104:107]
  v_mfma_f32_16x16x16_bf16 v[108:111], v[78:79], v[190:191], v[108:111]
  v_mfma_f32_16x16x16_bf16 v[112:115], v[80:81], v[190:191], v[112:115]
  v_mfma_f32_16x16x16_bf16 v[116:119], v[82:83], v[190:191], v[116:119]
  v_mfma_f32_16x16x16_bf16 v[120:123], v[84:85], v[190:191], v[120:123]
  v_mfma_f32_16x16x16_bf16 v[124:127], v[86:87], v[190:191], v[124:127]
  v_mfma_f32_16x16x16_bf16 v[128:131], v[88:89], v[190:191], v[128:131]
  v_mfma_f32_16x16x16_bf16 v[132:135], v[90:91], v[190:191], v[132:135]
  v_mfma_f32_16x16x16_bf16 v[136:139], v[92:93], v[190:191], v[136:139]
  v_mfma_f32_16x16x16_bf16 v[140:143], v[94:95], v[190:191], v[140:143]
  s_waitcnt vmcnt(5)
  buffer_load_dwordx4 v3, s[44:47], s54 offen offset:1024 nt lds
  s_add_u32 s53, s53, 6144
  s_cmp_ge_u32 s53, 36864
  s_cselect_b32 s53, 0, s53
  v_add_u32 v17, s53, v13
  v_add_u32 v18, s53, v14
  v_add_u32 v19, s53, v15
  v_add_u32 v20, s53, v16
  ds_read_b64_tr_b16 v[48:49], v17 offset:0
  ds_read_b64_tr_b16 v[50:51], v18 offset:0
  ds_read_b64_tr_b16 v[52:53], v19 offset:0
  ds_read_b64_tr_b16 v[54:55], v20 offset:0
  ds_read_b64_tr_b16 v[56:57], v17 offset:128
  ds_read_b64_tr_b16 v[58:59], v18 offset:128
  ds_read_b64_tr_b16 v[60:61], v19 offset:128
  ds_read_b64_tr_b16 v[62:63], v20 offset:128
  ds_read_b64_tr_b16 v[64:65], v17 offset:256
  ds_read_b64_tr_b16 v[66:67], v18 offset:256
  ds_read_b64_tr_b16 v[68:69], v19 offset:256
  ds_read_b64_tr_b16 v[70:71], v20 offset:256
  s_waitcnt vmcnt(5)
  buffer_load_dwordx4 v4, s[44:47], s54 offen offset:2048 nt lds
  v_mov_b32_dpp v168, v168 row_ror:1 row_mask:0xf bank_mask:0xf
  v_mov_b32_dpp v169, v169 row_ror:1 row_mask:0xf bank_mask:0xf
  v_cndmask_b32 v190, 0, v168, s[50:51]
  v_cndmask_b32 v191, 0, v169, s[50:51]
  s_waitcnt vmcnt(5)
  buffer_load_dwordx4 v5, s[44:47], s54 offen offset:3072 nt lds
  s_add_u32 m0, s62, 4096
  s_waitcnt vmcnt(5)
  buffer_load_dwordx4 v6, s[44:47], s59 offen offset:0 nt lds
  s_waitcnt vmcnt(5)
  buffer_load_dwordx4 v7, s[44:47], s59 offen offset:1024 nt lds
  s_add_u32 s89, s89, 196608
  s_cmp_ge_u32 s89, 3145728
  s_cselect_b32 s57, 3145728, 0
  s_sub_u32 s89, s89, s57
  s_add_u32 s88, s88, 1
  s_and_b32 s57, s88, 15
  s_cselect_b32 s57, 0, 100663296
  s_add_u32 s73, s73, s57
  s_add_u32 s54, s73, s89
  s_add_u32 s59, s54, 4096
  s_memrealtime s[76:77]
  s_waitcnt lgkmcnt(0)
  s_add_u32 s58, s58, 1
  s_sub_u32 s55, s55, 1
  s_branch L_dispV
L_bV13:
  s_add_u32 s62, s52, s53
  s_mov_b32 m0, s62
  s_waitcnt vmcnt(5)
  buffer_load_dwordx4 v2, s[44:47], s54 offen offset:0 nt lds
  v_mfma_f32_16x16x16_bf16 v[96:99], v[48:49], v[190:191], v[96:99]
  v_mfma_f32_16x16x16_bf16 v[100:103], v[50:51], v[190:191], v[100:103]
  v_mfma_f32_16x16x16_bf16 v[104:107], v[52:53], v[190:191], v[104:107]
  v_mfma_f32_16x16x16_bf16 v[108:111], v[54:55], v[190:191], v[108:111]
  v_mfma_f32_16x16x16_bf16 v[112:115], v[56:57], v[190:191], v[112:115]
  v_mfma_f32_16x16x16_bf16 v[116:119], v[58:59], v[190:191], v[116:119]
  v_mfma_f32_16x16x16_bf16 v[120:123], v[60:61], v[190:191], v[120:123]
  v_mfma_f32_16x16x16_bf16 v[124:127], v[62:63], v[190:191], v[124:127]
  v_mfma_f32_16x16x16_bf16 v[128:131], v[64:65], v[190:191], v[128:131]
  v_mfma_f32_16x16x16_bf16 v[132:135], v[66:67], v[190:191], v[132:135]
  v_mfma_f32_16x16x16_bf16 v[136:139], v[68:69], v[190:191], v[136:139]
  v_mfma_f32_16x16x16_bf16 v[140:143], v[70:71], v[190:191], v[140:143]
  s_waitcnt vmcnt(6)
  buffer_load_dwordx4 v3, s[44:47], s54 offen offset:1024 nt lds
  s_add_u32 s53, s53, 6144
  s_cmp_ge_u32 s53, 36864
  s_cselect_b32 s53, 0, s53
  v_add_u32 v17, s53, v13
  v_add_u32 v18, s53, v14
  v_add_u32 v19, s53, v15
  v_add_u32 v20, s53, v16
  ds_read_b64_tr_b16 v[72:73], v17 offset:0
  ds_read_b64_tr_b16 v[74:75], v18 offset:0
  ds_read_b64_tr_b16 v[76:77], v19 offset:0
  ds_read_b64_tr_b16 v[78:79], v20 offset:0
  ds_read_b64_tr_b16 v[80:81], v17 offset:128
  ds_read_b64_tr_b16 v[82:83], v18 offset:128
  ds_read_b64_tr_b16 v[84:85], v19 offset:128
  ds_read_b64_tr_b16 v[86:87], v20 offset:128
  ds_read_b64_tr_b16 v[88:89], v17 offset:256
  ds_read_b64_tr_b16 v[90:91], v18 offset:256
  ds_read_b64_tr_b16 v[92:93], v19 offset:256
  ds_read_b64_tr_b16 v[94:95], v20 offset:256
  s_waitcnt vmcnt(5)
  buffer_load_dwordx4 v4, s[44:47], s54 offen offset:2048 nt lds
  v_mov_b32_dpp v168, v168 row_ror:1 row_mask:0xf bank_mask:0xf
  v_mov_b32_dpp v169, v169 row_ror:1 row_mask:0xf bank_mask:0xf
  v_cndmask_b32 v190, 0, v168, s[50:51]
  v_cndmask_b32 v191, 0, v169, s[50:51]
  s_waitcnt vmcnt(6)
  buffer_load_dwordx4 v5, s[44:47], s54 offen offset:3072 nt lds
  s_add_u32 m0, s62, 4096
  s_waitcnt vmcnt(5)
  buffer_load_dwordx4 v6, s[44:47], s59 offen offset:0 nt lds
  s_waitcnt vmcnt(6)
  buffer_load_dwordx4 v7, s[44:47], s59 offen offset:1024 nt lds
  s_add_u32 s89, s89, 196608
  s_cmp_ge_u32 s89, 3145728
  s_cselect_b32 s57, 3145728, 0
  s_sub_u32 s89, s89, s57
  s_add_u32 s88, s88, 1
  s_and_b32 s57, s88, 15
  s_cselect_b32 s57, 0, 100663296
  s_add_u32 s73, s73, s57
  s_add_u32 s54, s73, s89
  s_add_u32 s59, s54, 4096
  s_waitcnt lgkmcnt(0)
L_oddV13:
  s_add_u32 s62, s52, s53
  s_mov_b32 m0, s62
  s_waitcnt vmcnt(5)
  buffer_load_dwordx4 v2, s[44:47], s54 offen offset:0 nt lds
  v_mfma_f32_16x16x16_bf16 v[96:99], v[72:73], v[190:191], v[96:99]
  v_mfma_f32_16x16x16_bf16 v[100:103], v[74:75], v[190:191], v[100:103]
  v_mfma_f32_16x16x16_bf16 v[104:107], v[76:77], v[190:191], v[104:107]
  v_mfma_f32_16x16x16_bf16 v[108:111], v[78:79], v[190:191], v[108:111]
  v_mfma_f32_16x16x16_bf16 v[112:115], v[80:81], v[190:191], v[112:115]
  v_mfma_f32_16x16x16_bf16 v[116:119], v[82:83], v[190:191], v[116:119]
  v_mfma_f32_16x16x16_bf16 v[120:123], v[84:85], v[190:191], v[120:123]
  v_mfma_f32_16x16x16_bf16 v[124:127], v[86:87], v[190:191], v[124:127]
  v_mfma_f32_16x16x16_bf16 v[128:131], v[88:89], v[190:191], v[128:131]
  v_mfma_f32_16x16x16_bf16 v[132:135], v[90:91], v[190:191], v[132:135]
  v_mfma_f32_16x16x16_bf16 v[136:139], v[92:93], v[190:191], v[136:139]
  v_mfma_f32_16x16x16_bf16 v[140:143], v[94:95], v[190:191], v[140:143]
  s_waitcnt vmcnt(6)
  buffer_load_dwordx4 v3, s[44:47], s54 offen offset:1024 nt lds
  s_add_u32 s53, s53, 6144
  s_cmp_ge_u32 s53, 36864
  s_cselect_b32 s53, 0, s53
  v_add_u32 v17, s53, v13
  v_add_u32 v18, s53, v14
  v_add_u32 v19, s53, v15
  v_add_u32 v20, s53, v16
  ds_read_b64_tr_b16 v[48:49], v17 offset:0
  ds_read_b64_tr_b16 v[50:51], v18 offset:0
  ds_read_b64_tr_b16 v[52:53], v19 offset:0
  ds_read_b64_tr_b16 v[54:55], v20 offset:0
  ds_read_b64_tr_b16 v[56:57], v17 offset:128
  ds_read_b64_tr_b16 v[58:59], v18 offset:128
  ds_read_b64_tr_b16 v[60:61], v19 offset:128
  ds_read_b64_tr_b16 v[62:63], v20 offset:128
  ds_read_b64_tr_b16 v[64:65], v17 offset:256
  ds_read_b64_tr_b16 v[66:67], v18 offset:256
  ds_read_b64_tr_b16 v[68:69], v19 offset:256
  ds_read_b64_tr_b16 v[70:71], v20 offset:256
  s_waitcnt vmcnt(5)
  buffer_load_dwordx4 v4, s[44:47], s54 offen offset:2048 nt lds
  v_mov_b32_dpp v168, v168 row_ror:1 row_mask:0xf bank_mask:0xf
  v_mov_b32_dpp v169, v169 row_ror:1 row_mask:0xf bank_mask:0xf
  v_cndmask_b32 v190, 0, v168, s[50:51]
  v_cndmask_b32 v191, 0, v169, s[50:51]
  s_waitcnt vmcnt(6)
  buffer_load_dwordx4 v5, s[44:47], s54 offen offset:3072 nt lds
  s_add_u32 m0, s62, 4096
  s_waitcnt vmcnt(5)
  buffer_load_dwordx4 v6, s[44:47], s59 offen offset:0 nt lds
  s_waitcnt vmcnt(6)
  buffer_load_dwordx4 v7, s[44:47], s59 offen offset:1024 nt lds
  s_add_u32 s89, s89, 196608
  s_cmp_ge_u32 s89, 3145728
  s_cselect_b32 s57, 3145728, 0
  s_sub_u32 s89, s89, s57
  s_add_u32 s88, s88, 1
  s_and_b32 s57, s88, 15
  s_cselect_b32 s57, 0, 100663296
  s_add_u32 s73, s73, s57
  s_add_u32 s54, s73, s89
  s_add_u32 s59, s54, 4096
  s_memrealtime s[76:77]
  s_waitcnt lgkmcnt(0)
  s_add_u32 s58, s58, 1
  s_sub_u32 s55, s55, 1
  s_branch L_dispV
L_bV14:
  s_add_u32 s62, s52, s53
  s_mov_b32 m0, s62
  s_waitcnt vmcnt(6)
  buffer_load_dwordx4 v2, s[44:47], s54 offen offset:0 nt lds
  v_mfma_f32_16x16x16_bf16 v[96:99], v[48:49], v[190:191], v[96:99]
  v_mfma_f32_16x16x16_bf16 v[100:103], v[50:51], v[190:191], v[100:103]
  v_mfma_f32_16x16x16_bf16 v[104:107], v[52:53], v[190:191], v[104:107]
  v_mfma_f32_16x16x16_bf16 v[108:111], v[54:55], v[190:191], v[108:111]
  v_mfma_f32_16x16x16_bf16 v[112:115], v[56:57], v[190:191], v[112:115]
  v_mfma_f32_16x16x16_bf16 v[116:119], v[58:59], v[190:191], v[116:119]
  v_mfma_f32_16x16x16_bf16 v[120:123], v[60:61], v[190:191], v[120:123]
  v_mfma_f32_16x16x16_bf16 v[124:127], v[62:63], v[190:191], v[124:127]
  v_mfma_f32_16x16x16_bf16 v[128:131], v[64:65], v[190:191], v[128:131]
  v_mfma_f32_16x16x16_bf16 v[132:135], v[66:67], v[190:191], v[132:135]
  v_mfma_f32_16x16x16_bf16 v[136:139], v[68:69], v[190:191], v[136:139]
  v_mfma_f32_16x16x16_bf16 v[140:143], v[70:71], v[190:191], v[140:143]
  s_waitcnt vmcnt(6)
  buffer_load_dwordx4 v3, s[44:47], s54 offen offset:1024 nt lds
  s_add_u32 s53, s53, 6144
  s_cmp_ge_u32 s53, 36864
  s_cselect_b32 s53, 0, s53
  v_add_u32 v17, s53, v13
  v_add_u32 v18, s53, v14
  v_add_u32 v19, s53, v15
  v_add_u32 v20, s53, v16
  ds_read_b64_tr_b16 v[72:73], v17 offset:0
  ds_read_b64_tr_b16 v[74:75], v18 offset:0
  ds_read_b64_tr_b16 v[76:77], v19 offset:0
  ds_read_b64_tr_b16 v[78:79], v20 offset:0
  ds_read_b64_tr_b16 v[80:81], v17 offset:128
  ds_read_b64_tr_b16 v[82:83], v18 offset:128
  ds_read_b64_tr_b16 v[84:85], v19 offset:128
  ds_read_b64_tr_b16 v[86:87], v20 offset:128
  ds_read_b64_tr_b16 v[88:89], v17 offset:256
  ds_read_b64_tr_b16 v[90:91], v18 offset:256
  ds_read_b64_tr_b16 v[92:93], v19 offset:256
  ds_read_b64_tr_b16 v[94:95], v20 offset:256
  s_waitcnt vmcnt(6)
  buffer_load_dwordx4 v4, s[44:47], s54 offen offset:2048 nt lds
  v_mov_b32_dpp v168, v168 row_ror:1 row_mask:0xf bank_mask:0xf
  v_mov_b32_dpp v169, v169 row_ror:1 row_mask:0xf bank_mask:0xf
  v_cndmask_b32 v190, 0, v168, s[50:51]
  v_cndmask_b32 v191, 0, v169, s[50:51]
  s_waitcnt vmcnt(6)
  buffer_load_dwordx4 v5, s[44:47], s54 offen offset:3072 nt lds
  s_add_u32 m0, s62, 4096
  s_waitcnt vmcnt(6)
  buffer_load_dwordx4 v6, s[44:47], s59 offen offset:0 nt lds
  s_waitcnt vmcnt(6)
  buffer_load_dwordx4 v7, s[44:47], s59 offen offset:1024 nt lds
  s_add_u32 s89, s89, 196608
  s_cmp_ge_u32 s89, 3145728
  s_cselect_b32 s57, 3145728, 0
  s_sub_u32 s89, s89, s57
  s_add_u32 s88, s88, 1
  s_and_b32 s57, s88, 15
  s_cselect_b32 s57, 0, 100663296
  s_add_u32 s73, s73, s57
  s_add_u32 s54, s73, s89
  s_add_u32 s59, s54, 4096
  s_waitcnt lgkmcnt(0)
L_oddV14:
  s_add_u32 s62, s52, s53
  s_mov_b32 m0, s62
  s_waitcnt vmcnt(6)
  buffer_load_dwordx4 v2, s[44:47], s54 offen offset:0 nt lds
  v_mfma_f32_16x16x16_bf16 v[96:99], v[72:73], v[190:191], v[96:99]
  v_mfma_f32_16x16x16_bf16 v[100:103], v[74:75], v[190:191], v[100:103]
  v_mfma_f32_16x16x16_bf16 v[104:107], v[76:77], v[190:191], v[104:107]
  v_mfma_f32_16x16x16_bf16 v[108:111], v[78:79], v[190:191], v[108:111]
  v_mfma_f32_16x16x16_bf16 v[112:115], v[80:81], v[190:191], v[112:115]
  v_mfma_f32_16x16x16_bf16 v[116:119], v[82:83], v[190:191], v[116:119]
  v_mfma_f32_16x16x16_bf16 v[120:123], v[84:85], v[190:191], v[120:123]
  v_mfma_f32_16x16x16_bf16 v[124:127], v[86:87], v[190:191], v[124:127]
  v_mfma_f32_16x16x16_bf16 v[128:131], v[88:89], v[190:191], v[128:131]
  v_mfma_f32_16x16x16_bf16 v[132:135], v[90:91], v[190:191], v[132:135]
  v_mfma_f32_16x16x16_bf16 v[136:139], v[92:93], v[190:191], v[136:139]
  v_mfma_f32_16x16x16_bf16 v[140:143], v[94:95], v[190:191], v[140:143]
  s_waitcnt vmcnt(6)
  buffer_load_dwordx4 v3, s[44:47], s54 offen offset:1024 nt lds
  s_add_u32 s53, s53, 6144
  s_cmp_ge_u32 s53, 36864
  s_cselect_b32 s53, 0, s53
  v_add_u32 v17, s53, v13
  v_add_u32 v18, s53, v14
  v_add_u32 v19, s53, v15
  v_add_u32 v20, s53, v16
  ds_read_b64_tr_b16 v[48:49], v17 offset:0
  ds_read_b64_tr_b16 v[50:51], v18 offset:0
  ds_read_b64_tr_b16 v[52:53], v19 offset:0
  ds_read_b64_tr_b16 v[54:55], v20 offset:0
  ds_read_b64_tr_b16 v[56:57], v17 offset:128
  ds_read_b64_tr_b16 v[58:59], v18 offset:128
  ds_read_b64_tr_b16 v[60:61], v19 offset:128
  ds_read_b64_tr_b16 v[62:63], v20 offset:128
  ds_read_b64_tr_b16 v[64:65], v17 offset:256
  ds_read_b64_tr_b16 v[66:67], v18 offset:256
  ds_read_b64_tr_b16 v[68:69], v19 offset:256
  ds_read_b64_tr_b16 v[70:71], v20 offset:256
  s_waitcnt vmcnt(6)
  buffer_load_dwordx4 v4, s[44:47], s54 offen offset:2048 nt lds
  v_mov_b32_dpp v168, v168 row_ror:1 row_mask:0xf bank_mask:0xf
  v_mov_b32_dpp v169, v169 row_ror:1 row_mask:0xf bank_mask:0xf
  v_cndmask_b32 v190, 0, v168, s[50:51]
  v_cndmask_b32 v191, 0, v169, s[50:51]
  s_waitcnt vmcnt(6)
  buffer_load_dwordx4 v5, s[44:47], s54 offen offset:3072 nt lds
  s_add_u32 m0, s62, 4096
  s_waitcnt vmcnt(6)
  buffer_load_dwordx4 v6, s[44:47], s59 offen offset:0 nt lds
  s_waitcnt vmcnt(6)
  buffer_load_dwordx4 v7, s[44:47], s59 offen offset:1024 nt lds
  s_add_u32 s89, s89, 196608
  s_cmp_ge_u32 s89, 3145728
  s_cselect_b32 s57, 3145728, 0
  s_sub_u32 s89, s89, s57
  s_add_u32 s88, s88, 1
  s_and_b32 s57, s88, 15
  s_cselect_b32 s57, 0, 100663296
  s_add_u32 s73, s73, s57
  s_add_u32 s54, s73, s89
  s_add_u32 s59, s54, 4096
  s_memrealtime s[76:77]
  s_waitcnt lgkmcnt(0)
  s_add_u32 s58, s58, 1
  s_sub_u32 s55, s55, 1
  s_branch L_dispV
L_bV16:
  s_add_u32 s62, s52, s53
  s_mov_b32 m0, s62
  s_waitcnt vmcnt(7)
  buffer_load_dwordx4 v2, s[44:47], s54 offen offset:0 nt lds
  v_mfma_f32_16x16x16_bf16 v[96:99], v[48:49], v[190:191], v[96:99]
  v_mfma_f32_16x16x16_bf16 v[100:103], v[50:51], v[190:191], v[100:103]
  v_mfma_f32_16x16x16_bf16 v[104:107], v[52:53], v[190:191], v[104:107]
  v_mfma_f32_16x16x16_bf16 v[108:111], v[54:55], v[190:191], v[108:111]
  v_mfma_f32_16x16x16_bf16 v[112:115], v[56:57], v[190:191], v[112:115]
  v_mfma_f32_16x16x16_bf16 v[116:119], v[58:59], v[190:191], v[116:119]
  v_mfma_f32_16x16x16_bf16 v[120:123], v[60:61], v[190:191], v[120:123]
  v_mfma_f32_16x16x16_bf16 v[124:127], v[62:63], v[190:191], v[124:127]
  v_mfma_f32_16x16x16_bf16 v[128:131], v[64:65], v[190:191], v[128:131]
  v_mfma_f32_16x16x16_bf16 v[132:135], v[66:67], v[190:191], v[132:135]
  v_mfma_f32_16x16x16_bf16 v[136:139], v[68:69], v[190:191], v[136:139]
  v_mfma_f32_16x16x16_bf16 v[140:143], v[70:71], v[190:191], v[140:143]
  s_waitcnt vmcnt(7)
  buffer_load_dwordx4 v3, s[44:47], s54 offen offset:1024 nt lds
  s_add_u32 s53, s53, 6144
  s_cmp_ge_u32 s53, 36864
  s_cselect_b32 s53, 0, s53
  v_add_u32 v17, s53, v13
  v_add_u32 v18, s53, v14
  v_add_u32 v19, s53, v15
  v_add_u32 v20, s53, v16
  ds_read_b64_tr_b16 v[72:73], v17 offset:0
  ds_read_b64_tr_b16 v[74:75], v18 offset:0
  ds_read_b64_tr_b16 v[76:77], v19 offset:0
  ds_read_b64_tr_b16 v[78:79], v20 offset:0
  ds_read_b64_tr_b16 v[80:81], v17 offset:128
  ds_read_b64_tr_b16 v[82:83], v18 offset:128
  ds_read_b64_tr_b16 v[84:85], v19 offset:128
  ds_read_b64_tr_b16 v[86:87], v20 offset:128
  ds_read_b64_tr_b16 v[88:89], v17 offset:256
  ds_read_b64_tr_b16 v[90:91], v18 offset:256
  ds_read_b64_tr_b16 v[92:93], v19 offset:256
  ds_read_b64_tr_b16 v[94:95], v20 offset:256
  s_waitcnt vmcnt(7)
  buffer_load_dwordx4 v4, s[44:47], s54 offen offset:2048 nt lds
  v_mov_b32_dpp v168, v168 row_ror:1 row_mask:0xf bank_mask:0xf
  v_mov_b32_dpp v169, v169 row_ror:1 row_mask:0xf bank_mask:0xf
  v_cndmask_b32 v190, 0, v168, s[50:51]
  v_cndmask_b32 v191, 0, v169, s[50:51]
  s_waitcnt vmcnt(7)
  buffer_load_dwordx4 v5, s[44:47], s54 offen offset:3072 nt lds
  s_add_u32 m0, s62, 4096
  s_waitcnt vmcnt(7)
  buffer_load_dwordx4 v6, s[44:47], s59 offen offset:0 nt lds
  s_waitcnt vmcnt(7)
  buffer_load_dwordx4 v7, s[44:47], s59 offen offset:1024 nt lds
  s_add_u32 s89, s89, 196608
  s_cmp_ge_u32 s89, 3145728
  s_cselect_b32 s57, 3145728, 0
  s_sub_u32 s89, s89, s57
  s_add_u32 s88, s88, 1
  s_and_b32 s57, s88, 15
  s_cselect_b32 s57, 0, 100663296
  s_add_u32 s73, s73, s57
  s_add_u32 s54, s73, s89
  s_add_u32 s59, s54, 4096
  s_waitcnt lgkmcnt(0)
L_oddV16:
  s_add_u32 s62, s52, s53
  s_mov_b32 m0, s62
  s_waitcnt vmcnt(7)
  buffer_load_dwordx4 v2, s[44:47], s54 offen offset:0 nt lds
  v_mfma_f32_16x16x16_bf16 v[96:99], v[72:73], v[190:191], v[96:99]
  v_mfma_f32_16x16x16_bf16 v[100:103], v[74:75], v[190:191], v[100:103]
  v_mfma_f32_16x16x16_bf16 v[104:107], v[76:77], v[190:191], v[104:107]
  v_mfma_f32_16x16x16_bf16 v[108:111], v[78:79], v[190:191], v[108:111]
  v_mfma_f32_16x16x16_bf16 v[112:115], v[80:81], v[190:191], v[112:115]
  v_mfma_f32_16x16x16_bf16 v[116:119], v[82:83], v[190:191], v[116:119]
  v_mfma_f32_16x16x16_bf16 v[120:123], v[84:85], v[190:191], v[120:123]
  v_mfma_f32_16x16x16_bf16 v[124:127], v[86:87], v[190:191], v[124:127]
  v_mfma_f32_16x16x16_bf16 v[128:131], v[88:89], v[190:191], v[128:131]
  v_mfma_f32_16x16x16_bf16 v[132:135], v[90:91], v[190:191], v[132:135]
  v_mfma_f32_16x16x16_bf16 v[136:139], v[92:93], v[190:191], v[136:139]
  v_mfma_f32_16x16x16_bf16 v[140:143], v[94:95], v[190:191], v[140:143]
  s_waitcnt vmcnt(7)
  buffer_load_dwordx4 v3, s[44:47], s54 offen offset:1024 nt lds
  s_add_u32 s53, s53, 6144
  s_cmp_ge_u32 s53, 36864
  s_cselect_b32 s53, 0, s53
  v_add_u32 v17, s53, v13
  v_add_u32 v18, s53, v14
  v_add_u32 v19, s53, v15
  v_add_u32 v20, s53, v16
  ds_read_b64_tr_b16 v[48:49], v17 offset:0
  ds_read_b64_tr_b16 v[50:51], v18 offset:0
  ds_read_b64_tr_b16 v[52:53], v19 offset:0
  ds_read_b64_tr_b16 v[54:55], v20 offset:0
  ds_read_b64_tr_b16 v[56:57], v17 offset:128
  ds_read_b64_tr_b16 v[58:59], v18 offset:128
  ds_read_b64_tr_b16 v[60:61], v19 offset:128
  ds_read_b64_tr_b16 v[62:63], v20 offset:128
  ds_read_b64_tr_b16 v[64:65], v17 offset:256
  ds_read_b64_tr_b16 v[66:67], v18 offset:256
  ds_read_b64_tr_b16 v[68:69], v19 offset:256
  ds_read_b64_tr_b16 v[70:71], v20 offset:256
  s_waitcnt vmcnt(7)
  buffer_load_dwordx4 v4, s[44:47], s54 offen offset:2048 nt lds
  v_mov_b32_dpp v168, v168 row_ror:1 row_mask:0xf bank_mask:0xf
  v_mov_b32_dpp v169, v169 row_ror:1 row_mask:0xf bank_mask:0xf
  v_cndmask_b32 v190, 0, v168, s[50:51]
  v_cndmask_b32 v191, 0, v169, s[50:51]
  s_waitcnt vmcnt(7)
  buffer_load_dwordx4 v5, s[44:47], s54 offen offset:3072 nt lds
  s_add_u32 m0, s62, 4096
  s_waitcnt vmcnt(7)
  buffer_load_dwordx4 v6, s[44:47], s59 offen offset:0 nt lds
  s_waitcnt vmcnt(7)
  buffer_load_dwordx4 v7, s[44:47], s59 offen offset:1024 nt lds
  s_add_u32 s89, s89, 196608
  s_cmp_ge_u32 s89, 3145728
  s_cselect_b32 s57, 3145728, 0
  s_sub_u32 s89, s89, s57
  s_add_u32 s88, s88, 1
  s_and_b32 s57, s88, 15
  s_cselect_b32 s57, 0, 100663296
  s_add_u32 s73, s73, s57
  s_add_u32 s54, s73, s89
  s_add_u32 s59, s54, 4096
  s_memrealtime s[76:77]
  s_waitcnt lgkmcnt(0)
  s_add_u32 s58, s58, 1
  s_sub_u32 s55, s55, 1
  s_branch L_dispV
L_outV:
  s_mov_b64 exec, 1
  ds_add_u32 v179, v180 offset:4
  s_mov_b64 exec, -1
  s_mov_b32 s55, 2
L_loopT:
  s_add_u32 s53, s53, 6144
  s_cmp_ge_u32 s53, 36864
  s_cselect_b32 s53, 0, s53
  s_waitcnt vmcnt(12)
  v_add_u32 v17, s53, v13
  v_add_u32 v18, s53, v14
  v_add_u32 v19, s53, v15
  v_add_u32 v20, s53, v16
  ds_read_b64_tr_b16 v[72:73], v17 offset:0
  ds_read_b64_tr_b16 v[74:75], v18 offset:0
  ds_read_b64_tr_b16 v[76:77], v19 offset:0
  ds_read_b64_tr_b16 v[78:79], v20 offset:0
  ds_read_b64_tr_b16 v[80:81], v17 offset:128
  ds_read_b64_tr_b16 v[82:83], v18 offset:128
  ds_read_b64_tr_b16 v[84:85], v19 offset:128
  ds_read_b64_tr_b16 v[86:87], v20 offset:128
  ds_read_b64_tr_b16 v[88:89], v17 offset:256
  ds_read_b64_tr_b16 v[90:91], v18 offset:256
  ds_read_b64_tr_b16 v[92:93], v19 offset:256
  ds_read_b64_tr_b16 v[94:95], v20 offset:256
  v_mfma_f32_16x16x16_bf16 v[96:99], v[48:49], v[190:191], v[96:99]
  v_mfma_f32_16x16x16_bf16 v[100:103], v[50:51], v[190:191], v[100:103]
  v_mfma_f32_16x16x16_bf16 v[104:107], v[52:53], v[190:191], v[104:107]
  v_mfma_f32_16x16x16_bf16 v[108:111], v[54:55], v[190:191], v[108:111]
  v_mfma_f32_16x16x16_bf16 v[112:115], v[56:57], v[190:191], v[112:115]
  v_mfma_f32_16x16x16_bf16 v[116:119], v[58:59], v[190:191], v[116:119]
  v_mfma_f32_16x16x16_bf16 v[120:123], v[60:61], v[190:191], v[120:123]
  v_mfma_f32_16x16x16_bf16 v[124:127], v[62:63], v[190:191], v[124:127]
  v_mfma_f32_16x16x16_bf16 v[128:131], v[64:65], v[190:191], v[128:131]
  v_mfma_f32_16x16x16_bf16 v[132:135], v[66:67], v[190:191], v[132:135]
  v_mfma_f32_16x16x16_bf16 v[136:139], v[68:69], v[190:191], v[136:139]
  v_mfma_f32_16x16x16_bf16 v[140:143], v[70:71], v[190:191], v[140:143]
  v_mov_b32_dpp v168, v168 row_ror:1 row_mask:0xf bank_mask:0xf
  v_mov_b32_dpp v169, v169 row_ror:1 row_mask:0xf bank_mask:0xf
  v_cndmask_b32 v190, 0, v168, s[50:51]
  v_cndmask_b32 v191, 0, v169, s[50:51]
  s_waitcnt lgkmcnt(0)
  s_add_u32 s53, s53, 6144
  s_cmp_ge_u32 s53, 36864
  s_cselect_b32 s53, 0, s53
  s_cmp_lg_u32 s55, 1
  s_cbranch_scc1 L_tnw
  s_waitcnt vmcnt(6)
L_tnw:
  v_add_u32 v17, s53, v13
  v_add_u32 v18, s53, v14
  v_add_u32 v19, s53, v15
  v_add_u32 v20, s53, v16
  ds_read_b64_tr_b16 v[48:49], v17 offset:0
  ds_read_b64_tr_b16 v[50:51], v18 offset:0
  ds_read_b64_tr_b16 v[52:53], v19 offset:0
  ds_read_b64_tr_b16 v[54:55], v20 offset:0
  ds_read_b64_tr_b16 v[56:57], v17 offset:128
  ds_read_b64_tr_b16 v[58:59], v18 offset:128
  ds_read_b64_tr_b16 v[60:61], v19 offset:128
  ds_read_b64_tr_b16 v[62:63], v20 offset:128
  ds_read_b64_tr_b16 v[64:65], v17 offset:256
  ds_read_b64_tr_b16 v[66:67], v18 offset:256
  ds_read_b64_tr_b16 v[68:69], v19 offset:256
  ds_read_b64_tr_b16 v[70:71], v20 offset:256
  v_mfma_f32_16x16x16_bf16 v[96:99], v[72:73], v[190:191], v[96:99]
  v_mfma_f32_16x16x16_bf16 v[100:103], v[74:75], v[190:191], v[100:103]
  v_mfma_f32_16x16x16_bf16 v[104:107], v[76:77], v[190:191], v[104:107]
  v_mfma_f32_16x16x16_bf16 v[108:111], v[78:79], v[190:191], v[108:111]
  v_mfma_f32_16x16x16_bf16 v[112:115], v[80:81], v[190:191], v[112:115]
  v_mfma_f32_16x16x16_bf16 v[116:119], v[82:83], v[190:191], v[116:119]
  v_mfma_f32_16x16x16_bf16 v[120:123], v[84:85], v[190:191], v[120:123]
  v_mfma_f32_16x16x16_bf16 v[124:127], v[86:87], v[190:191], v[124:127]
  v_mfma_f32_16x16x16_bf16 v[128:131], v[88:89], v[190:191], v[128:131]
  v_mfma_f32_16x16x16_bf16 v[132:135], v[90:91], v[190:191], v[132:135]
  v_mfma_f32_16x16x16_bf16 v[136:139], v[92:93], v[190:191], v[136:139]
  v_mfma_f32_16x16x16_bf16 v[140:143], v[94:95], v[190:191], v[140:143]
  v_mov_b32_dpp v168, v168 row_ror:1 row_mask:0xf bank_mask:0xf
  v_mov_b32_dpp v169, v169 row_ror:1 row_mask:0xf bank_mask:0xf
  v_cndmask_b32 v190, 0, v168, s[50:51]
  v_cndmask_b32 v191, 0, v169, s[50:51]
  s_waitcnt lgkmcnt(0)
  s_sub_u32 s55, s55, 1
  s_cmp_lg_u32 s55, 0
  s_cbranch_scc1 L_loopT
  v_mfma_f32_16x16x16_bf16 v[96:99], v[48:49], v[190:191], v[96:99]
  v_mfma_f32_16x16x16_bf16 v[100:103], v[50:51], v[190:191], v[100:103]
  v_mfma_f32_16x16x16_bf16 v[104:107], v[52:53], v[190:191], v[104:107]
  v_mfma_f32_16x16x16_bf16 v[108:111], v[54:55], v[190:191], v[108:111]
  v_mfma_f32_16x16x16_bf16 v[112:115], v[56:57], v[190:191], v[112:115]
  v_mfma_f32_16x16x16_bf16 v[116:119], v[58:59], v[190:191], v[116:119]
  v_mfma_f32_16x16x16_bf16 v[120:123], v[60:61], v[190:191], v[120:123]
  v_mfma_f32_16x16x16_bf16 v[124:127], v[62:63], v[190:191], v[124:127]
  v_mfma_f32_16x16x16_bf16 v[128:131], v[64:65], v[190:191], v[128:131]
  v_mfma_f32_16x16x16_bf16 v[132:135], v[66:67], v[190:191], v[132:135]
  v_mfma_f32_16x16x16_bf16 v[136:139], v[68:69], v[190:191], v[136:139]
  v_mfma_f32_16x16x16_bf16 v[140:143], v[70:71], v[190:191], v[140:143]
  v_mov_b32_dpp v168, v168 row_ror:1 row_mask:0xf bank_mask:0xf
  v_mov_b32_dpp v169, v169 row_ror:1 row_mask:0xf bank_mask:0xf
  v_cndmask_b32 v190, 0, v168, s[50:51]
  v_cndmask_b32 v191, 0, v169, s[50:51]
  s_add_u32 s53, s53, 6144
  s_cmp_ge_u32 s53, 36864
  s_cselect_b32 s53, 0, s53
  v_add_u32 v17, s53, v13
  v_add_u32 v18, s53, v14
  v_add_u32 v19, s53, v15
  v_add_u32 v20, s53, v16
  v_mov_b32 v176, 148992
  s_mov_b32 s98, s99
L_facw:
  ds_read_b32 v177, v176 offset:20
  s_waitcnt lgkmcnt(0)
  v_cmp_le_u32 vcc, 1, v177
  s_cbranch_vccnz L_facwd
  s_sleep 1
  s_sub_u32 s98, s98, 1
  s_cmp_lg_u32 s98, 0
  s_cbranch_scc1 L_facw
L_facwd:
  ds_read_b128 v[192:195], v176 offset:240
  v_lshlrev_b32 v181, 4, v0
  v_add_u32 v177, 151808, v181
  s_mul_i32 s56, s63, 3072
  s_add_u32 s56, s56, 985344
  v_mov_b32 v197, v185
  v_mov_b32 v199, v185
  s_waitcnt vmcnt(0) lgkmcnt(0)
  ds_read_b64_tr_b16 v[72:73], v17 offset:0
  ds_read_b64_tr_b16 v[74:75], v18 offset:0
  ds_read_b64_tr_b16 v[76:77], v19 offset:0
  ds_read_b64_tr_b16 v[78:79], v20 offset:0
  ds_read_b64_tr_b16 v[80:81], v17 offset:128
  ds_read_b64_tr_b16 v[82:83], v18 offset:128
  ds_read_b64_tr_b16 v[84:85], v19 offset:128
  ds_read_b64_tr_b16 v[86:87], v20 offset:128
  ds_read_b64_tr_b16 v[88:89], v17 offset:256
  ds_read_b64_tr_b16 v[90:91], v18 offset:256
  ds_read_b64_tr_b16 v[92:93], v19 offset:256
  ds_read_b64_tr_b16 v[94:95], v20 offset:256
  s_waitcnt lgkmcnt(11)
  v_mfma_f32_16x16x16_bf16 v[96:99], v[72:73], v[190:191], v[96:99]
  s_waitcnt lgkmcnt(10)
  v_mfma_f32_16x16x16_bf16 v[100:103], v[74:75], v[190:191], v[100:103]
  s_waitcnt lgkmcnt(9)
  v_mfma_f32_16x16x16_bf16 v[104:107], v[76:77], v[190:191], v[104:107]
  s_waitcnt lgkmcnt(8)
  v_mfma_f32_16x16x16_bf16 v[108:111], v[78:79], v[190:191], v[108:111]
  s_waitcnt lgkmcnt(7)
  v_mfma_f32_16x16x16_bf16 v[112:115], v[80:81], v[190:191], v[112:115]
  s_waitcnt lgkmcnt(6)
  v_mfma_f32_16x16x16_bf16 v[116:119], v[82:83], v[190:191], v[116:119]
  s_waitcnt lgkmcnt(5)
  v_mfma_f32_16x16x16_bf16 v[120:123], v[84:85], v[190:191], v[120:123]
  s_waitcnt lgkmcnt(4)
  v_mfma_f32_16x16x16_bf16 v[124:127], v[86:87], v[190:191], v[124:127]
  s_waitcnt lgkmcnt(3)
  v_mfma_f32_16x16x16_bf16 v[128:131], v[88:89], v[190:191], v[128:131]
  s_waitcnt lgkmcnt(2)
  v_mfma_f32_16x16x16_bf16 v[132:135], v[90:91], v[190:191], v[132:135]
  s_waitcnt lgkmcnt(1)
  v_mfma_f32_16x16x16_bf16 v[136:139], v[92:93], v[190:191], v[136:139]
  s_waitcnt lgkmcnt(0)
  v_mfma_f32_16x16x16_bf16 v[140:143], v[94:95], v[190:191], v[140:143]
  s_mov_b32 exec_lo, 0x80008000
  s_mov_b32 exec_hi, 0x80008000
  ds_write_b128 v178, v[96:99] offset:0
  ds_write_b128 v178, v[100:103] offset:64
  ds_write_b128 v178, v[104:107] offset:128
  ds_write_b128 v178, v[108:111] offset:192
  ds_write_b128 v178, v[112:115] offset:256
  ds_write_b128 v178, v[116:119] offset:320
  ds_write_b128 v178, v[120:123] offset:384
  ds_write_b128 v178, v[124:127] offset:448
  ds_write_b128 v178, v[128:131] offset:512
  ds_write_b128 v178, v[132:135] offset:576
  ds_write_b128 v178, v[136:139] offset:640
  ds_write_b128 v178, v[140:143] offset:704
  s_mov_b64 exec, 1
  ds_add_rtn_u32 v176, v179, v180 offset:8
  s_waitcnt lgkmcnt(0)
  v_cmp_ne_u32 vcc, 3, v176
  s_cbranch_vccnz L_sdone
  s_bfm_b64 exec, 48, 0
  ds_read_b128 v[96:99], v177 offset:0
  ds_read_b128 v[100:103], v177 offset:3072
  ds_read_b128 v[104:107], v177 offset:6144
  ds_read_b128 v[108:111], v177 offset:9216
  s_waitcnt lgkmcnt(3)
  v_mul_f32 v112, v96, v192
  v_mul_f32 v113, v97, v192
  v_mul_f32 v114, v98, v192
  v_mul_f32 v115, v99, v192
  s_waitcnt lgkmcnt(2)
  v_fmac_f32 v112, v100, v193
  v_fmac_f32 v113, v101, v193
  v_fmac_f32 v114, v102, v193
  v_fmac_f32 v115, v103, v193
  s_waitcnt lgkmcnt(1)
  v_fmac_f32 v112, v104, v194
  v_fmac_f32 v113, v105, v194
  v_fmac_f32 v114, v106, v194
  v_fmac_f32 v115, v107, v194
  s_waitcnt lgkmcnt(0)
  v_fmac_f32 v112, v108, v195
  v_fmac_f32 v113, v109, v195
  v_fmac_f32 v114, v110, v195
  v_fmac_f32 v115, v111, v195
  v_cvt_pk_bf16_f32 v196, v112, v113
  v_cvt_pk_bf16_f32 v198, v114, v115
  buffer_store_dwordx4 v[196:199], v181, s[64:67], s56 offen sc1
L_sdone:
  s_endpgm
L_h3:
  v_mov_b32 v12, 148992
  s_mov_b32 s98, s99
L_h3w:
  ds_read_b32 v13, v12 offset:0
  s_waitcnt lgkmcnt(0)
  v_cmp_le_u32 vcc, 1, v13
  s_cbranch_vccnz L_h3wd
  s_sleep 8
  s_sub_u32 s98, s98, 1
  s_cmp_lg_u32 s98, 0
  s_cbranch_scc1 L_h3w
L_h3wd:
  ds_read_b32 v13, v12 offset:12
  s_waitcnt lgkmcnt(0)
  v_readfirstlane_b32 s42, v13
  s_and_b32 s46, s2, 7
  s_mul_i32 s46, s46, 40
  s_lshr_b32 s47, s2, 3
  s_add_u32 s46, s46, s47
  s_cmp_eq_u32 s3, 2
  s_cselect_b32 s47, 8, 0
  s_add_u32 s46, s46, s47
  s_mul_i32 s44, s46, 820
  s_lshr_b32 s44, s44, 16
  s_mul_i32 s45, s44, 80
  s_sub_u32 s45, s46, s45
  s_mul_i32 s46, s44, 1280
  s_add_u32 s68, s16, s46
  s_addc_u32 s69, s17, 0
  s_mov_b32 s70, 1280
  s_mov_b32 s71, 0x00020000
  s_mov_b32 s72, s34
  s_mov_b32 s73, s35
  s_mov_b32 s74, 1280
  s_mov_b32 s75, 0x00020000
  v_lshlrev_b32 v7, 4, v0
  buffer_load_dwordx4 v[16:19], v7, s[68:71], 0 offen
  buffer_load_dwordx4 v[20:23], v7, s[68:71], 0 offen offset:1024
  buffer_load_dwordx4 v[24:27], v7, s[72:75], 0 offen
  buffer_load_dwordx4 v[28:31], v7, s[72:75], 0 offen offset:1024
  v_mov_b32 v8, 0
  s_waitcnt vmcnt(0)
  v_lshlrev_b32 v32, 16, v16
  v_lshlrev_b32 v33, 16, v24
  v_and_b32 v34, 0xffff0000, v16
  v_and_b32 v35, 0xffff0000, v24
  v_mul_f32 v32, v32, v33
  v_mul_f32 v34, v34, v35
  v_cvt_pk_bf16_f32 v32, v32, v34
  v_lshlrev_b32 v33, 16, v32
  v_and_b32 v32, 0xffff0000, v32
  v_add_f32 v8, v8, v33
  v_add_f32 v8, v8, v32
  v_lshlrev_b32 v32, 16, v17
  v_lshlrev_b32 v33, 16, v25
  v_and_b32 v34, 0xffff0000, v17
  v_and_b32 v35, 0xffff0000, v25
  v_mul_f32 v32, v32, v33
  v_mul_f32 v34, v34, v35
  v_cvt_pk_bf16_f32 v32, v32, v34
  v_lshlrev_b32 v33, 16, v32
  v_and_b32 v32, 0xffff0000, v32
  v_add_f32 v8, v8, v33
  v_add_f32 v8, v8, v32
  v_lshlrev_b32 v32, 16, v18
  v_lshlrev_b32 v33, 16, v26
  v_and_b32 v34, 0xffff0000, v18
  v_and_b32 v35, 0xffff0000, v26
  v_mul_f32 v32, v32, v33
  v_mul_f32 v34, v34, v35
  v_cvt_pk_bf16_f32 v32, v32, v34
  v_lshlrev_b32 v33, 16, v32
  v_and_b32 v32, 0xffff0000, v32
  v_add_f32 v8, v8, v33
  v_add_f32 v8, v8, v32
  v_lshlrev_b32 v32, 16, v19
  v_lshlrev_b32 v33, 16, v27
  v_and_b32 v34, 0xffff0000, v19
  v_and_b32 v35, 0xffff0000, v27
  v_mul_f32 v32, v32, v33
  v_mul_f32 v34, v34, v35
  v_cvt_pk_bf16_f32 v32, v32, v34
  v_lshlrev_b32 v33, 16, v32
  v_and_b32 v32, 0xffff0000, v32
  v_add_f32 v8, v8, v33
  v_add_f32 v8, v8, v32
  v_lshlrev_b32 v32, 16, v20
  v_lshlrev_b32 v33, 16, v28
  v_and_b32 v34, 0xffff0000, v20
  v_and_b32 v35, 0xffff0000, v28
  v_mul_f32 v32, v32, v33
  v_mul_f32 v34, v34, v35
  v_cvt_pk_bf16_f32 v32, v32, v34
  v_lshlrev_b32 v33, 16, v32
  v_and_b32 v32, 0xffff0000, v32
  v_add_f32 v8, v8, v33
  v_add_f32 v8, v8, v32
  v_lshlrev_b32 v32, 16, v21
  v_lshlrev_b32 v33, 16, v29
  v_and_b32 v34, 0xffff0000, v21
  v_and_b32 v35, 0xffff0000, v29
  v_mul_f32 v32, v32, v33
  v_mul_f32 v34, v34, v35
  v_cvt_pk_bf16_f32 v32, v32, v34
  v_lshlrev_b32 v33, 16, v32
  v_and_b32 v32, 0xffff0000, v32
  v_add_f32 v8, v8, v33
  v_add_f32 v8, v8, v32
  v_lshlrev_b32 v32, 16, v22
  v_lshlrev_b32 v33, 16, v30
  v_and_b32 v34, 0xffff0000, v22
  v_and_b32 v35, 0xffff0000, v30
  v_mul_f32 v32, v32, v33
  v_mul_f32 v34, v34, v35
  v_cvt_pk_bf16_f32 v32, v32, v34
  v_lshlrev_b32 v33, 16, v32
  v_and_b32 v32, 0xffff0000, v32
  v_add_f32 v8, v8, v33
  v_add_f32 v8, v8, v32
  v_lshlrev_b32 v32, 16, v23
  v_lshlrev_b32 v33, 16, v31
  v_and_b32 v34, 0xffff0000, v23
  v_and_b32 v35, 0xffff0000, v31
  v_mul_f32 v32, v32, v33
  v_mul_f32 v34, v34, v35
  v_cvt_pk_bf16_f32 v32, v32, v34
  v_lshlrev_b32 v33, 16, v32
  v_and_b32 v32, 0xffff0000, v32
  v_add_f32 v8, v8, v33
  v_add_f32 v8, v8, v32
  s_nop 1
  s_nop 1
  v_add_f32_dpp v8, v8, v8 row_ror:8 row_mask:0xf bank_mask:0xf
  s_nop 1
  v_add_f32_dpp v8, v8, v8 row_ror:4 row_mask:0xf bank_mask:0xf
  s_nop 1
  v_add_f32_dpp v8, v8, v8 row_ror:2 row_mask:0xf bank_mask:0xf
  s_nop 1
  v_add_f32_dpp v8, v8, v8 row_ror:1 row_mask:0xf bank_mask:0xf
  v_mov_b32 v9, v8
  s_nop 1
  v_permlane32_swap_b32 v8, v9
  v_add_f32 v8, v8, v9
  v_mov_b32 v9, v8
  s_nop 1
  v_permlane16_swap_b32 v8, v9
  v_add_f32 v8, v8, v9
  v_cvt_pk_bf16_f32 v8, v8, v8
  v_and_b32 v8, 0xffff0000, v8
  v_mul_f32 v8, 0xbfb8aa3b, v8
  v_exp_f32 v8, v8
  s_nop 0
  v_add_f32 v8, 1.0, v8
  v_rcp_f32 v8, v8
  s_nop 0
  v_cvt_pk_bf16_f32 v8, v8, v8
  v_and_b32 v8, 0xffff0000, v8
  v_sub_f32 v9, 1.0, v8
  v_cvt_pk_bf16_f32 v9, v9, v9
  v_and_b32 v9, 0xffff0000, v9
  v_mul_u32_u24 v10, 10240, v0
  s_mul_i32 s49, s44, 2560
  s_lshl_b32 s50, s45, 5
  s_add_u32 s49, s49, s50
  s_add_u32 s49, s49, 327680
  s_lshr_b32 s46, s45, 4
  s_bfe_u32 s47, s45, 0x10003
  s_and_b32 s48, s45, 7
  s_lshl_b32 s46, s46, 8
  s_lshl_b32 s47, s47, 3
  s_lshl_b32 s48, s48, 5
  s_add_u32 s46, s46, s47
  s_add_u32 s46, s46, s48
  v_lshlrev_b32 v12, 4, v5
  v_lshl_add_u32 v12, v6, 1, v12
  v_add_u32 v12, s46, v12
  s_mul_i32 s46, s44, 1280
  s_add_u32 s68, s36, s46
  s_addc_u32 s69, s37, 0
  s_mov_b32 s70, 1280
  s_mov_b32 s71, 0x00020000
  v_cmp_eq_u32 s[74:75], 1, v1
  v_cmp_eq_u32 s[76:77], 2, v1
  v_cmp_eq_u32 s[78:79], 3, v1
  v_cmp_eq_u32 s[80:81], 4, v1
  v_cmp_eq_u32 s[82:83], 5, v1
  v_cmp_eq_u32 s[84:85], 6, v1
  v_cmp_eq_u32 s[86:87], 7, v1
L_h3e:
  v_mov_b32 v16, 0
  v_mov_b32 v17, 0
  v_mov_b32 v18, 0
  v_mov_b32 v19, 0
  v_mov_b32 v20, 0
  v_mov_b32 v21, 0
  v_mov_b32 v22, 0
  v_mov_b32 v23, 0
  s_bfm_b64 s[52:53], 60, 0
  s_movk_i32 s50, 0xff00
  s_barrier
L_h3nb:
  s_mov_b64 s[96:97], s[52:53]
L_h3poll:
  s_mov_b64 exec, s[96:97]
  buffer_load_dwordx4 v[16:19], v10, s[64:67], s49 offen offset:0 sc1
  buffer_load_dwordx4 v[20:23], v10, s[64:67], s49 offen offset:16 sc1
L_h3chk:
  s_waitcnt vmcnt(0)
  v_cmpx_eq_u32_sdwa vcc, v13, v16 src0_sel:BYTE_0 src1_sel:BYTE_0
  v_cmpx_eq_u32_sdwa vcc, v13, v17 src0_sel:BYTE_0 src1_sel:BYTE_0
  v_cmpx_eq_u32_sdwa vcc, v13, v18 src0_sel:BYTE_0 src1_sel:BYTE_0
  v_cmpx_eq_u32_sdwa vcc, v13, v19 src0_sel:BYTE_0 src1_sel:BYTE_0
  v_cmpx_eq_u32_sdwa vcc, v13, v20 src0_sel:BYTE_0 src1_sel:BYTE_0
  v_cmpx_eq_u32_sdwa vcc, v13, v21 src0_sel:BYTE_0 src1_sel:BYTE_0
  v_cmpx_eq_u32_sdwa vcc, v13, v22 src0_sel:BYTE_0 src1_sel:BYTE_0
  v_cmpx_eq_u32_sdwa vcc, v13, v23 src0_sel:BYTE_0 src1_sel:BYTE_0
  s_nop 1
  s_andn2_b64 s[96:97], s[96:97], exec
  s_cbranch_scc0 L_h3go
  s_sleep 2
  s_sub_u32 s51, s51, 1
  s_cmp_lg_u32 s51, 0
  s_cbranch_scc1 L_h3poll
L_h3go:
  s_mov_b64 exec, s[52:53]
  s_nop 3
  s_mov_b64 exec, -1
  v_and_b32 v16, s50, v16
  v_and_b32 v17, s50, v17
  v_and_b32 v18, s50, v18
  v_and_b32 v19, s50, v19
  v_and_b32 v20, s50, v20
  v_and_b32 v21, s50, v21
  v_and_b32 v22, s50, v22
  v_and_b32 v23, s50, v23
  s_nop 1
  v_add_f32_dpp v16, v16, v16 row_ror:8 row_mask:0xf bank_mask:0xf
  v_add_f32_dpp v17, v17, v17 row_ror:8 row_mask:0xf bank_mask:0xf
  v_add_f32_dpp v18, v18, v18 row_ror:8 row_mask:0xf bank_mask:0xf
  v_add_f32_dpp v19, v19, v19 row_ror:8 row_mask:0xf bank_mask:0xf
  v_add_f32_dpp v20, v20, v20 row_ror:8 row_mask:0xf bank_mask:0xf
  v_add_f32_dpp v21, v21, v21 row_ror:8 row_mask:0xf bank_mask:0xf
  v_add_f32_dpp v22, v22, v22 row_ror:8 row_mask:0xf bank_mask:0xf
  v_add_f32_dpp v23, v23, v23 row_ror:8 row_mask:0xf bank_mask:0xf
  v_add_f32_dpp v16, v16, v16 row_ror:4 row_mask:0xf bank_mask:0xf
  v_add_f32_dpp v17, v17, v17 row_ror:4 row_mask:0xf bank_mask:0xf
  v_add_f32_dpp v18, v18, v18 row_ror:4 row_mask:0xf bank_mask:0xf
  v_add_f32_dpp v19, v19, v19 row_ror:4 row_mask:0xf bank_mask:0xf
  v_add_f32_dpp v20, v20, v20 row_ror:4 row_mask:0xf bank_mask:0xf
  v_add_f32_dpp v21, v21, v21 row_ror:4 row_mask:0xf bank_mask:0xf
  v_add_f32_dpp v22, v22, v22 row_ror:4 row_mask:0xf bank_mask:0xf
  v_add_f32_dpp v23, v23, v23 row_ror:4 row_mask:0xf bank_mask:0xf
  v_add_f32_dpp v16, v16, v16 row_ror:2 row_mask:0xf bank_mask:0xf
  v_add_f32_dpp v17, v17, v17 row_ror:2 row_mask:0xf bank_mask:0xf
  v_add_f32_dpp v18, v18, v18 row_ror:2 row_mask:0xf bank_mask:0xf
  v_add_f32_dpp v19, v19, v19 row_ror:2 row_mask:0xf bank_mask:0xf
  v_add_f32_dpp v20, v20, v20 row_ror:2 row_mask:0xf bank_mask:0xf
  v_add_f32_dpp v21, v21, v21 row_ror:2 row_mask:0xf bank_mask:0xf
  v_add_f32_dpp v22, v22, v22 row_ror:2 row_mask:0xf bank_mask:0xf
  v_add_f32_dpp v23, v23, v23 row_ror:2 row_mask:0xf bank_mask:0xf
  v_add_f32_dpp v16, v16, v16 row_ror:1 row_mask:0xf bank_mask:0xf
  v_add_f32_dpp v17, v17, v17 row_ror:1 row_mask:0xf bank_mask:0xf
  v_add_f32_dpp v18, v18, v18 row_ror:1 row_mask:0xf bank_mask:0xf
  v_add_f32_dpp v19, v19, v19 row_ror:1 row_mask:0xf bank_mask:0xf
  v_add_f32_dpp v20, v20, v20 row_ror:1 row_mask:0xf bank_mask:0xf
  v_add_f32_dpp v21, v21, v21 row_ror:1 row_mask:0xf bank_mask:0xf
  v_add_f32_dpp v22, v22, v22 row_ror:1 row_mask:0xf bank_mask:0xf
  v_add_f32_dpp v23, v23, v23 row_ror:1 row_mask:0xf bank_mask:0xf
  v_cndmask_b32 v16, v16, v17, s[74:75]
  v_cndmask_b32 v16, v16, v18, s[76:77]
  v_cndmask_b32 v16, v16, v19, s[78:79]
  v_cndmask_b32 v16, v16, v20, s[80:81]
  v_cndmask_b32 v16, v16, v21, s[82:83]
  v_cndmask_b32 v16, v16, v22, s[84:85]
  v_cndmask_b32 v16, v16, v23, s[86:87]
  v_mov_b32 v17, v16
  s_nop 1
  v_permlane32_swap_b32 v16, v17
  v_mov_b32 v18, v16
  v_mov_b32 v19, v17
  s_nop 1
  v_permlane16_swap_b32 v16, v18
  v_permlane16_swap_b32 v17, v19
  v_add_f32 v16, v16, v18
  v_add_f32 v16, v16, v17
  v_cvt_pk_bf16_f32 v16, v16, v16
  v_and_b32 v16, 0xffff0000, v16
  v_cvt_pk_bf16_f32 v19, v19, v19
  v_and_b32 v19, 0xffff0000, v19
  v_mul_f32 v16, v16, v8
  v_mul_f32 v19, v19, v9
  v_cvt_pk_bf16_f32 v16, v16, v16
  v_and_b32 v16, 0xffff0000, v16
  v_cvt_pk_bf16_f32 v19, v19, v19
  v_and_b32 v19, 0xffff0000, v19
  v_add_f32 v16, v16, v19
  s_nop 1
  v_mov_b32_dpp v17, v16 quad_perm:[1,0,3,2] row_mask:0xf bank_mask:0xf
  v_cvt_pk_bf16_f32 v16, v16, v17
  s_mov_b64 exec, 0x55
  buffer_store_dword v16, v12, s[68:71], 0 offen sc1
  s_cmp_lg_u32 s2, 0
  s_cbranch_scc1 L_h3done
  s_mov_b64 exec, 1
  v_mov_b32 v18, 0
  buffer_store_dword v13, v18, s[64:67], 0 offen sc1
L_h3done:
  s_endpgm
L_end:
  s_endpgm
.section .rodata,"a"
.p2align 6
.amdhsa_kernel gated_mix__mha_block_cached__glu_gated_swiglu__decode_kernel
  .amdhsa_next_free_vgpr 256
  .amdhsa_next_free_sgpr 102
  .amdhsa_accum_offset 256
  .amdhsa_group_segment_fixed_size 0
  .amdhsa_kernarg_size 104
  .amdhsa_user_sgpr_count 2
  .amdhsa_user_sgpr_kernarg_segment_ptr 1
  .amdhsa_system_sgpr_workgroup_id_x 1
.end_amdhsa_kernel
```
